```python
import torch

def _softmax(x, axis=-1):
    return torch.softmax(x, dim=axis)
def _gelu(x):
    return torch.nn.functional.gelu(x, approximate="tanh")
def _silu(x):
    return torch.nn.functional.silu(x)
def _sigmoid(x):
    return torch.sigmoid(x)
def _layernorm(x, axis=-1, eps=1e-5):
    m = x.mean(dim=axis, keepdim=True)
    v = x.var(dim=axis, keepdim=True, unbiased=False)
    return (x - m) / torch.sqrt(v + eps)
def _scatter_add(tgt, idx, src, axis=0):
    return tgt.clone().index_add_(axis, idx, src)
def _segment_sum(src, seg, n):
    out = torch.zeros((n,) + src.shape[1:], dtype=src.dtype)
    return out.index_add_(0, seg, src)
def _pad(x, pw):
    flat = tuple(v for pair in reversed(pw) for v in pair)
    return torch.nn.functional.pad(x, flat)

kernel_name = 'gated_mix__softmax_full_mha__swiglu_ffn__prompt'

def setup_inputs():

    _w = (lambda a: (lambda t: t.to(torch.bfloat16) if t.is_floating_point() else t)(torch.as_tensor(a)))
    def _A_setup():
        B, S, D = 1, 2048, 1024
        return {
            "x": _w((lambda *s: torch.randn(*s, dtype=torch.bfloat16) * 0.05)(B, S, D)),
            "wqkv": _w((lambda *s: torch.randn(*s, dtype=torch.bfloat16) * 0.8)(D, 3 * D)),
            "wo": _w((lambda *s: torch.randn(*s, dtype=torch.bfloat16) * 0.05)(D, D)),
        }
    _A_in = _A_setup()

    def _B_setup():
        B, S, D, F = 1, 2048, 1024, 3584
        return {
            "x": _w((lambda *s: torch.randn(*s, dtype=torch.bfloat16) * 0.05)(B, S, D)),
            "w_gate": _w((lambda *s: torch.randn(*s, dtype=torch.bfloat16) * 0.1)(D, F)),
            "w_up": _w((lambda *s: torch.randn(*s, dtype=torch.bfloat16) * 0.1)(D, F)),
            "w_down": _w((lambda *s: torch.randn(*s, dtype=torch.bfloat16) * 0.1)(F, D)),
        }
    _B_in = _B_setup()

    return {
        "A_x": _A_in["x"],
        "A_wqkv": _A_in["wqkv"],
        "A_wo": _A_in["wo"],
        "B_x": _B_in["x"],
        "B_w_gate": _B_in["w_gate"],
        "B_w_up": _B_in["w_up"],
        "B_w_down": _B_in["w_down"],
        "gate_w": _w((lambda *s: torch.randn(*s, dtype=torch.bfloat16) * 0.05)(1024) * 16.0),
    }

def reference(A_x, A_wqkv, A_wo, B_x, B_w_gate, B_w_up, B_w_down, gate_w):
    def _A_ref(x, wqkv, wo):
        B, S, D = x.shape
        H = 32; Dh = D // H
        qkv = (lambda x, *d: x.permute(*d))((x @ wqkv).reshape(B, S, 3, H, Dh), 2, 0, 3, 1, 4)
        q, k, v = qkv[0], qkv[1], qkv[2]
        scale = Dh ** -0.5
        scores = torch.einsum("bhqd,bhkd->bhqk", q, k) * scale
        p = _softmax(scores, axis=-1)
        o = torch.einsum("bhqk,bhkd->bhqd", p, v)
        return (lambda x, *d: x.permute(*d))(o, 0, 2, 1, 3).reshape(B, S, D) @ wo

    def _B_ref(x, w_gate, w_up, w_down):
        g = _silu(x @ w_gate)
        u = x @ w_up
        return (g * u) @ w_down

    x = A_x
    g = _sigmoid((x * gate_w).sum(-1, keepdims=True))
    a = _A_ref(x, A_wqkv, A_wo)
    b = _B_ref(x, B_w_gate, B_w_up, B_w_down)
    return g * a + (1 - g) * b
```

```asm
; @launch kernel=k1_kernel grid=(256,1,1) block=(256,1,1) lds=147456
; @launch kernel=k2_kernel grid=(512,1,1) block=(512,1,1) lds=81920
.amdgcn_target "amdgcn-amd-amdhsa--gfx950"
.text
.globl k1_kernel
.p2align 8
.type k1_kernel,@function
k1_kernel:
    s_cmp_ge_u32 s2, 256
    s_cbranch_scc1 k1_kernel_end
    s_load_dwordx4 s[60:63], s[0:1], 0
    s_load_dwordx8 s[64:71], s[0:1], 32
    s_getpc_b64 s[24:25]
k1_kernel_pc0:
    s_mov_b32 s26, k1_kernel_pc-k1_kernel_pc0
    s_mov_b32 s27, 0x20000
    s_lshr_b32 s50, s2, 3
    s_lshl_b32 s50, s50, 10
    v_lshlrev_b32 v16, 2, v0
    buffer_load_dword v47, v16, s[24:27], s50 offen
    s_load_dwordx2 s[72:73], s[0:1], 80
    s_load_dwordx2 s[74:75], s[0:1], 16
    v_lshrrev_b32 v16, 6, v0
    v_and_b32 v0, 63, v0
    v_readfirstlane_b32 s38, v16
    s_and_b32 s50, s2, 7
    s_lshr_b32 s51, s2, 3
    s_and_b32 s41, s51, 7
    s_lshr_b32 s51, s51, 3
    s_lshl_b32 s42, s50, 2
    s_add_u32 s42, s42, s51
    s_lshr_b32 s39, s38, 1
    s_and_b32 s40, s38, 1
    s_and_b32 s48, s42, 1
    s_lshr_b32 s50, s42, 1
    s_mul_i32 s45, s50, 224
    s_lshl_b32 s51, s48, 7
    s_add_u32 s45, s45, s51
    s_lshl_b32 s47, s50, 6
    s_add_u32 s46, s47, 1024
    s_lshl_b32 s52, s48, 11
    s_add_u32 s47, s47, s52
    s_movk_i32 s52, 7168
    s_cmp_eq_u32 s48, 1
    s_cselect_b32 s53, 6144, s52
    s_lshl_b32 s54, s40, 5
    s_add_u32 s55, s46, s54
    s_add_u32 s56, s45, 96
    s_cmp_eq_u32 s48, 1
    s_cselect_b32 s55, s55, s56
    s_add_u32 s56, s47, s54
    s_mov_b32 s32, 229376
    s_lshl_b32 s33, s53, 5
    s_mov_b32 s34, 196608
    s_and_b32 s49, s2, 7
    s_lshl_b32 s28, s49, 8
    s_lshl_b32 s49, s49, 2
    s_mul_i32 s29, s49, s32
    s_mul_i32 s30, s49, s33
    s_mul_i32 s31, s49, s34
    s_lshl_b32 s35, s38, 13
    s_mul_i32 s36, s39, 10240
    s_mul_i32 s50, s40, 5120
    s_add_u32 s36, s36, s50
    v_lshrrev_b32 v17, 2, v0
    s_lshl_b32 s50, s39, 4
    v_add_u32 v17, s50, v17
    v_lshrrev_b32 v18, 5, v0
    v_lshlrev_b32 v18, 1, v18
    v_and_b32 v19, 3, v0
    v_xor_b32 v18, v18, v19
    v_lshlrev_b32 v18, 4, v18
    v_mul_u32_u24 v9, 7168, v17
    v_mul_lo_u32 v10, v17, s53
    v_mul_u32_u24 v11, 6144, v17
    s_lshl_b32 s50, s45, 1
    s_lshl_b32 s55, s55, 1
    s_lshl_b32 s56, s56, 1
    v_add3_u32 v9, v9, v18, s50
    v_add3_u32 v10, v10, v18, s55
    v_add3_u32 v11, v11, v18, s56
    v_lshrrev_b32 v17, 3, v0
    s_lshl_b32 s50, s41, 8
    s_lshl_b32 s51, s38, 6
    s_add_u32 s50, s50, s51
    v_add_u32 v17, s50, v17
    v_lshlrev_b32 v17, 11, v17
    v_and_b32 v18, 7, v0
    v_lshrrev_b32 v19, 4, v0
    v_xor_b32 v18, v18, v19
    v_lshlrev_b32 v18, 4, v18
    v_add_u32 v17, v17, v18
    v_xor_b32 v18, 64, v17
    v_add_u32 v1, 0, v17
    v_add_u32 v2, 16384, v18
    v_add_u32 v3, 32768, v17
    v_add_u32 v4, 49152, v18
    v_add_u32 v5, 65536, v17
    v_add_u32 v6, 81920, v18
    v_add_u32 v7, 98304, v17
    v_add_u32 v8, 114688, v18
    v_lshlrev_b32 v18, 4, v0
    s_lshl_b32 s50, s2, 3
    s_lshl_b32 s51, s38, 1
    s_add_u32 s58, s50, s51
    s_lshl_b32 s59, s58, 11
    s_waitcnt lgkmcnt(0)
    s_mov_b32 s4, s60
    s_mov_b32 s5, s61
    s_mov_b32 s6, 4194304
    s_mov_b32 s7, 0x20000
    s_cmp_eq_u32 s40, 0
    s_cselect_b32 s8, s64, s66
    s_cselect_b32 s9, s65, s67
    s_mov_b32 s10, 7340032
    s_mov_b32 s11, 0x20000
    s_cmp_eq_u32 s48, 1
    s_cselect_b32 s12, s62, s8
    s_cselect_b32 s13, s63, s9
    s_lshl_b32 s14, s53, 10
    s_mov_b32 s15, 0x20000
    s_mov_b32 s16, s62
    s_mov_b32 s17, s63
    s_mov_b32 s18, 6291456
    s_mov_b32 s19, 0x20000
    s_add_u32 m0, s36, 65536
    s_nop 0
    buffer_load_dwordx4 v9, s[8:11], s29 offen offset:0  lds
    s_add_u32 s49, s49, 1
    s_add_u32 m0, s36, 66496
    s_nop 0
    buffer_load_dwordx4 v9, s[8:11], s29 offen offset:64  lds
    s_and_b32 s49, s49, 31
    s_add_u32 m0, s36, 67456
    s_nop 0
    buffer_load_dwordx4 v9, s[8:11], s29 offen offset:128  lds
    s_mul_i32 s29, s49, s32
    s_add_u32 m0, s36, 68608
    s_nop 0
    buffer_load_dwordx4 v10, s[12:15], s30 offen offset:0  lds
    s_mul_i32 s30, s49, s33
    s_add_u32 m0, s36, 69632
    s_nop 0
    buffer_load_dwordx4 v11, s[16:19], s31 offen offset:0  lds
    s_mul_i32 s31, s49, s34
    s_add_u32 m0, s35, 0
    s_nop 0
    buffer_load_dwordx4 v1, s[4:7], s28 offen  lds
    s_add_u32 m0, s35, 1024
    s_nop 0
    buffer_load_dwordx4 v2, s[4:7], s28 offen  lds
    s_add_u32 m0, s35, 2048
    s_nop 0
    buffer_load_dwordx4 v3, s[4:7], s28 offen  lds
    s_add_u32 m0, s35, 3072
    s_nop 0
    buffer_load_dwordx4 v4, s[4:7], s28 offen  lds
    s_add_u32 m0, s35, 4096
    s_nop 0
    buffer_load_dwordx4 v5, s[4:7], s28 offen  lds
    s_add_u32 m0, s35, 5120
    s_nop 0
    buffer_load_dwordx4 v6, s[4:7], s28 offen  lds
    s_add_u32 m0, s35, 6144
    s_nop 0
    buffer_load_dwordx4 v7, s[4:7], s28 offen  lds
    s_add_u32 m0, s35, 7168
    s_nop 0
    buffer_load_dwordx4 v8, s[4:7], s28 offen  lds
    s_add_u32 s28, s28, 128
    s_and_b32 s28, s28, 2047
    s_mov_b32 s80, s70
    s_mov_b32 s81, s71
    s_mov_b32 s82, 2048
    s_mov_b32 s83, 0x20000
    s_mov_b32 s20, s72
    s_mov_b32 s21, s73
    s_mov_b32 s22, 0x10000000
    s_mov_b32 s23, 0x20000
    s_cmp_eq_u32 s38, 0
    s_cselect_b32 s24, s62, s64
    s_cselect_b32 s25, s63, s65
    s_cselect_b32 s50, 24, 28
    s_cmp_eq_u32 s38, 2
    s_cselect_b32 s24, s66, s24
    s_cselect_b32 s25, s67, s25
    s_lshl_b32 s26, s50, 18
    s_lshl_b32 s44, s50, 14
    s_mov_b32 s27, 0x20000
    s_and_b32 s51, s2, 7
    s_lshl_b32 s3, s51, 1
    s_add_u32 s3, s3, 1
    s_lshl_b32 s52, s51, 5
    s_lshr_b32 s54, s2, 3
    s_lshl_b32 s55, s54, 9
    s_add_u32 s52, s52, s55
    s_lshl_b32 s55, s54, 6
    s_cmp_eq_u32 s38, 3
    s_cselect_b32 s24, s60, s24
    s_cselect_b32 s25, s61, s25
    s_cselect_b32 s26, s6, s26
    s_cselect_b32 s50, 0x800, s50
    s_cselect_b32 s44, 0x80, s44
    s_cselect_b32 s52, s55, s52
    s_cselect_b32 s54, 5, 8
    s_mul_i32 s43, s3, s44
    v_lshrrev_b32 v19, 5, v0
    v_lshlrev_b32 v19, s54, v19
    v_and_b32 v16, 31, v0
    v_add3_u32 v16, v16, v19, s52
    v_mul_lo_u32 v16, v16, s50
    v_bfe_u32 v19, v0, 3, 2
    v_min_u32 v19, 2, v19
    v_lshlrev_b32 v19, 11, v19
    v_and_b32 v44, 7, v0
    v_lshl_add_u32 v19, v44, 5, v19
    v_lshrrev_b32 v44, 5, v0
    s_lshr_b32 s54, s2, 3
    s_lshl_b32 s54, s54, 1
    v_add_u32 v44, s54, v44
    v_mul_u32_u24 v44, 6144, v44
    s_lshl_b32 s54, s51, 8
    v_add3_u32 v19, v19, v44, s54
    s_cmp_eq_u32 s38, 0
    s_cselect_b64 vcc, -1, 0
    v_cndmask_b32 v16, v16, v19, vcc
    s_add_u32 m0, s36, 86016
    s_nop 0
    buffer_load_dwordx4 v9, s[8:11], s29 offen offset:0  lds
    s_add_u32 s49, s49, 1
    s_add_u32 m0, s36, 86976
    s_nop 0
    buffer_load_dwordx4 v9, s[8:11], s29 offen offset:64  lds
    s_and_b32 s49, s49, 31
    s_add_u32 m0, s36, 87936
    s_nop 0
    buffer_load_dwordx4 v9, s[8:11], s29 offen offset:128  lds
    s_mul_i32 s29, s49, s32
    s_add_u32 m0, s36, 89088
    s_nop 0
    buffer_load_dwordx4 v10, s[12:15], s30 offen offset:0  lds
    s_mul_i32 s30, s49, s33
    s_add_u32 m0, s36, 90112
    s_nop 0
    buffer_load_dwordx4 v11, s[16:19], s31 offen offset:0  lds
    s_mul_i32 s31, s49, s34
    buffer_load_dword v17, v16, s[24:27], s43 offen
    s_add_u32 s3, s3, 1
    s_and_b32 s3, s3, 15
    s_mul_i32 s43, s3, s44
    s_lshl_b32 s55, s2, 6
    v_add_u32 v19, s55, v0
    v_lshlrev_b32 v19, 5, v19
    s_cmp_eq_u32 s38, 3
    s_cselect_b32 s24, s68, s24
    s_cselect_b32 s25, s69, s25
    s_cselect_b32 s26, s10, s26
    s_cselect_b32 s44, 0x80000, s44
    s_cselect_b32 s3, 0, s3
    s_cselect_b32 s43, 0, s43
    s_cselect_b64 vcc, -1, 0
    v_cndmask_b32 v16, v16, v19, vcc
    v_and_b32 v44, 15, v0
    v_lshrrev_b32 v46, 4, v0
    v_lshrrev_b32 v19, 1, v44
    v_xor_b32 v19, v19, v46
    v_lshlrev_b32 v19, 4, v19
    v_lshl_add_u32 v19, v44, 7, v19
    s_lshl_b32 s50, s39, 14
    v_add_u32 v12, s50, v19
    v_xor_b32 v13, 64, v12
    v_lshrrev_b32 v19, 5, v0
    v_mul_u32_u24 v19, 10240, v19
    v_and_b32 v45, 1, v46
    v_lshl_add_u32 v19, v45, 9, v19
    v_xor_b32 v45, s40, v45
    v_lshl_add_u32 v19, v45, 5, v19
    v_lshrrev_b32 v45, 2, v44
    v_lshl_add_u32 v19, v45, 6, v19
    v_and_b32 v45, 3, v44
    v_lshl_add_u32 v19, v45, 3, v19
    v_add_u32 v14, 65536, v19
    v_add_u32 v15, 106496, v19
    s_waitcnt vmcnt(6)
    s_barrier
    ds_read_b64_tr_b16 a[144:145], v14 offset:0
    ds_read_b64_tr_b16 a[146:147], v14 offset:256
    ds_read_b128 a[112:115], v12 offset:0
    ds_read_b128 a[116:119], v12 offset:2048
    ds_read_b128 a[120:123], v12 offset:4096
    ds_read_b128 a[124:127], v12 offset:6144
    ds_read_b128 a[128:131], v12 offset:8192
    ds_read_b128 a[132:135], v12 offset:10240
    ds_read_b128 a[136:139], v12 offset:12288
    ds_read_b128 a[140:143], v12 offset:14336
    ds_read_b64_tr_b16 a[164:165], v14 offset:5120
    ds_read_b64_tr_b16 a[166:167], v14 offset:5376
    ds_read_b64_tr_b16 a[148:149], v14 offset:1024
    ds_read_b64_tr_b16 a[150:151], v14 offset:1280
    ds_read_b64_tr_b16 a[168:169], v14 offset:6144
    ds_read_b64_tr_b16 a[170:171], v14 offset:6400
    ds_read_b64_tr_b16 a[152:153], v14 offset:2048
    ds_read_b64_tr_b16 a[154:155], v14 offset:2304
    ds_read_b64_tr_b16 a[172:173], v14 offset:7168
    ds_read_b64_tr_b16 a[174:175], v14 offset:7424
    ds_read_b64_tr_b16 a[156:157], v14 offset:3072
    ds_read_b64_tr_b16 a[158:159], v14 offset:3328
    ds_read_b64_tr_b16 a[176:177], v14 offset:8192
    ds_read_b64_tr_b16 a[178:179], v14 offset:8448
    ds_read_b64_tr_b16 a[160:161], v14 offset:4096
    ds_read_b64_tr_b16 a[162:163], v14 offset:4352
    ds_read_b64_tr_b16 a[180:181], v14 offset:9216
    ds_read_b64_tr_b16 a[182:183], v14 offset:9472
    s_mov_b32 s37, 6
    s_waitcnt vmcnt(1) lgkmcnt(0)
    s_barrier
    v_mfma_f32_16x16x32_bf16 v[48:51], a[144:147], a[112:115], 0
    ds_read_b64_tr_b16 a[216:217], v14 offset:20480
    v_mfma_f32_16x16x32_bf16 v[52:55], a[144:147], a[116:119], 0
    s_add_u32 m0, s36, 106496
    v_mfma_f32_16x16x32_bf16 v[56:59], a[144:147], a[120:123], 0
    ds_read_b64_tr_b16 a[218:219], v14 offset:20736
    v_mfma_f32_16x16x32_bf16 v[60:63], a[144:147], a[124:127], 0
    buffer_load_dwordx4 v9, s[8:11], s29 offen offset:0  lds
    v_mfma_f32_16x16x32_bf16 v[64:67], a[144:147], a[128:131], 0
    ds_read_b128 a[184:187], v13 offset:0
    v_mfma_f32_16x16x32_bf16 v[68:71], a[144:147], a[132:135], 0
    s_add_u32 s49, s49, 1
    v_mfma_f32_16x16x32_bf16 v[72:75], a[144:147], a[136:139], 0
    ds_read_b128 a[188:191], v13 offset:2048
    v_mfma_f32_16x16x32_bf16 v[76:79], a[144:147], a[140:143], 0
    s_add_u32 m0, s36, 107456
    v_mfma_f32_16x16x32_bf16 v[80:83], a[164:167], a[112:115], 0
    ds_read_b128 a[192:195], v13 offset:4096
    v_mfma_f32_16x16x32_bf16 v[84:87], a[164:167], a[116:119], 0
    buffer_load_dwordx4 v9, s[8:11], s29 offen offset:64  lds
    v_mfma_f32_16x16x32_bf16 v[88:91], a[164:167], a[120:123], 0
    ds_read_b128 a[196:199], v13 offset:6144
    v_mfma_f32_16x16x32_bf16 v[92:95], a[164:167], a[124:127], 0
    s_and_b32 s49, s49, 31
    v_mfma_f32_16x16x32_bf16 v[96:99], a[164:167], a[128:131], 0
    ds_read_b128 a[200:203], v13 offset:8192
    v_mfma_f32_16x16x32_bf16 v[100:103], a[164:167], a[132:135], 0
    s_add_u32 m0, s36, 108416
    v_mfma_f32_16x16x32_bf16 v[104:107], a[164:167], a[136:139], 0
    ds_read_b128 a[204:207], v13 offset:10240
    v_mfma_f32_16x16x32_bf16 v[108:111], a[164:167], a[140:143], 0
    buffer_load_dwordx4 v9, s[8:11], s29 offen offset:128  lds
    v_mfma_f32_16x16x32_bf16 v[112:115], a[148:151], a[112:115], 0
    ds_read_b128 a[208:211], v13 offset:12288
    v_mfma_f32_16x16x32_bf16 v[116:119], a[148:151], a[116:119], 0
    s_mul_i32 s29, s49, s32
    v_mfma_f32_16x16x32_bf16 v[120:123], a[148:151], a[120:123], 0
    ds_read_b128 a[212:215], v13 offset:14336
    v_mfma_f32_16x16x32_bf16 v[124:127], a[148:151], a[124:127], 0
    s_add_u32 m0, s36, 109568
    v_mfma_f32_16x16x32_bf16 v[128:131], a[148:151], a[128:131], 0
    ds_read_b64_tr_b16 a[236:237], v14 offset:25600
    v_mfma_f32_16x16x32_bf16 v[132:135], a[148:151], a[132:135], 0
    buffer_load_dwordx4 v10, s[12:15], s30 offen offset:0  lds
    v_mfma_f32_16x16x32_bf16 v[136:139], a[148:151], a[136:139], 0
    ds_read_b64_tr_b16 a[238:239], v14 offset:25856
    v_mfma_f32_16x16x32_bf16 v[140:143], a[148:151], a[140:143], 0
    s_mul_i32 s30, s49, s33
    v_mfma_f32_16x16x32_bf16 v[144:147], a[168:171], a[112:115], 0
    ds_read_b64_tr_b16 a[220:221], v14 offset:21504
    v_mfma_f32_16x16x32_bf16 v[148:151], a[168:171], a[116:119], 0
    s_add_u32 m0, s36, 110592
    v_mfma_f32_16x16x32_bf16 v[152:155], a[168:171], a[120:123], 0
    ds_read_b64_tr_b16 a[222:223], v14 offset:21760
    v_mfma_f32_16x16x32_bf16 v[156:159], a[168:171], a[124:127], 0
    buffer_load_dwordx4 v11, s[16:19], s31 offen offset:0  lds
    v_mfma_f32_16x16x32_bf16 v[160:163], a[168:171], a[128:131], 0
    ds_read_b64_tr_b16 a[240:241], v14 offset:26624
    v_mfma_f32_16x16x32_bf16 v[164:167], a[168:171], a[132:135], 0
    s_mul_i32 s31, s49, s34
    v_mfma_f32_16x16x32_bf16 v[168:171], a[168:171], a[136:139], 0
    ds_read_b64_tr_b16 a[242:243], v14 offset:26880
    v_mfma_f32_16x16x32_bf16 v[172:175], a[168:171], a[140:143], 0
    s_add_u32 m0, s35, 32768
    v_mfma_f32_16x16x32_bf16 v[176:179], a[152:155], a[112:115], 0
    ds_read_b64_tr_b16 a[224:225], v14 offset:22528
    v_mfma_f32_16x16x32_bf16 v[180:183], a[152:155], a[116:119], 0
    buffer_load_dwordx4 v1, s[4:7], s28 offen  lds
    v_mfma_f32_16x16x32_bf16 v[184:187], a[152:155], a[120:123], 0
    ds_read_b64_tr_b16 a[226:227], v14 offset:22784
    v_mfma_f32_16x16x32_bf16 v[188:191], a[152:155], a[124:127], 0
    s_add_u32 m0, s35, 33792
    v_mfma_f32_16x16x32_bf16 v[192:195], a[152:155], a[128:131], 0
    ds_read_b64_tr_b16 a[244:245], v14 offset:27648
    v_mfma_f32_16x16x32_bf16 v[196:199], a[152:155], a[132:135], 0
    buffer_load_dwordx4 v2, s[4:7], s28 offen  lds
    v_mfma_f32_16x16x32_bf16 v[200:203], a[152:155], a[136:139], 0
    ds_read_b64_tr_b16 a[246:247], v14 offset:27904
    v_mfma_f32_16x16x32_bf16 v[204:207], a[152:155], a[140:143], 0
    s_add_u32 m0, s35, 34816
    v_mfma_f32_16x16x32_bf16 v[208:211], a[172:175], a[112:115], 0
    ds_read_b64_tr_b16 a[228:229], v14 offset:23552
    v_mfma_f32_16x16x32_bf16 v[212:215], a[172:175], a[116:119], 0
    buffer_load_dwordx4 v3, s[4:7], s28 offen  lds
    v_mfma_f32_16x16x32_bf16 v[216:219], a[172:175], a[120:123], 0
    ds_read_b64_tr_b16 a[230:231], v14 offset:23808
    v_mfma_f32_16x16x32_bf16 v[220:223], a[172:175], a[124:127], 0
    s_add_u32 m0, s35, 35840
    v_mfma_f32_16x16x32_bf16 v[224:227], a[172:175], a[128:131], 0
    ds_read_b64_tr_b16 a[248:249], v14 offset:28672
    v_mfma_f32_16x16x32_bf16 v[228:231], a[172:175], a[132:135], 0
    buffer_load_dwordx4 v4, s[4:7], s28 offen  lds
    v_mfma_f32_16x16x32_bf16 v[232:235], a[172:175], a[136:139], 0
    ds_read_b64_tr_b16 a[250:251], v14 offset:28928
    v_mfma_f32_16x16x32_bf16 v[236:239], a[172:175], a[140:143], 0
    s_add_u32 m0, s35, 36864
    v_mfma_f32_16x16x32_bf16 v[240:243], a[156:159], a[112:115], 0
    ds_read_b64_tr_b16 a[232:233], v14 offset:24576
    buffer_load_dwordx4 v5, s[4:7], s28 offen  lds
    v_mfma_f32_16x16x32_bf16 v[244:247], a[156:159], a[116:119], 0
    s_add_u32 m0, s35, 37888
    v_mfma_f32_16x16x32_bf16 v[248:251], a[156:159], a[120:123], 0
    ds_read_b64_tr_b16 a[234:235], v14 offset:24832
    buffer_load_dwordx4 v6, s[4:7], s28 offen  lds
    v_mfma_f32_16x16x32_bf16 v[252:255], a[156:159], a[124:127], 0
    s_add_u32 m0, s35, 38912
    v_mfma_f32_16x16x32_bf16 a[0:3], a[156:159], a[128:131], 0
    ds_read_b64_tr_b16 a[252:253], v14 offset:29696
    buffer_load_dwordx4 v7, s[4:7], s28 offen  lds
    v_mfma_f32_16x16x32_bf16 a[4:7], a[156:159], a[132:135], 0
    s_add_u32 m0, s35, 39936
    v_mfma_f32_16x16x32_bf16 a[8:11], a[156:159], a[136:139], 0
    ds_read_b64_tr_b16 a[254:255], v14 offset:29952
    buffer_load_dwordx4 v8, s[4:7], s28 offen  lds
    v_mfma_f32_16x16x32_bf16 a[12:15], a[156:159], a[140:143], 0
    s_add_u32 s28, s28, 128
    v_mfma_f32_16x16x32_bf16 a[16:19], a[176:179], a[112:115], 0
    s_and_b32 s28, s28, 2047
    s_add_u32 m0, s36, 126976
    v_mfma_f32_16x16x32_bf16 a[20:23], a[176:179], a[116:119], 0
    buffer_load_dwordx4 v9, s[8:11], s29 offen offset:0  lds
    v_mfma_f32_16x16x32_bf16 a[24:27], a[176:179], a[120:123], 0
    s_add_u32 s49, s49, 1
    s_add_u32 m0, s36, 127936
    v_mfma_f32_16x16x32_bf16 a[28:31], a[176:179], a[124:127], 0
    buffer_load_dwordx4 v9, s[8:11], s29 offen offset:64  lds
    v_mfma_f32_16x16x32_bf16 a[32:35], a[176:179], a[128:131], 0
    s_and_b32 s49, s49, 31
    s_add_u32 m0, s36, 128896
    v_mfma_f32_16x16x32_bf16 a[36:39], a[176:179], a[132:135], 0
    buffer_load_dwordx4 v9, s[8:11], s29 offen offset:128  lds
    v_mfma_f32_16x16x32_bf16 a[40:43], a[176:179], a[136:139], 0
    s_mul_i32 s29, s49, s32
    s_add_u32 m0, s36, 130048
    v_mfma_f32_16x16x32_bf16 a[44:47], a[176:179], a[140:143], 0
    buffer_load_dwordx4 v10, s[12:15], s30 offen offset:0  lds
    v_mfma_f32_16x16x32_bf16 a[48:51], a[160:163], a[112:115], 0
    s_mul_i32 s30, s49, s33
    s_add_u32 m0, s36, 131072
    v_mfma_f32_16x16x32_bf16 a[52:55], a[160:163], a[116:119], 0
    buffer_load_dwordx4 v11, s[16:19], s31 offen offset:0  lds
    v_mfma_f32_16x16x32_bf16 a[56:59], a[160:163], a[120:123], 0
    s_mul_i32 s31, s49, s34
    s_add_u32 m0, s36, 65536
    v_mfma_f32_16x16x32_bf16 a[60:63], a[160:163], a[124:127], 0
    buffer_load_dwordx4 v9, s[8:11], s29 offen offset:0  lds
    v_mfma_f32_16x16x32_bf16 a[64:67], a[160:163], a[128:131], 0
    s_add_u32 s49, s49, 1
    s_add_u32 m0, s36, 66496
    v_mfma_f32_16x16x32_bf16 a[68:71], a[160:163], a[132:135], 0
    buffer_load_dwordx4 v9, s[8:11], s29 offen offset:64  lds
    v_mfma_f32_16x16x32_bf16 a[72:75], a[160:163], a[136:139], 0
    s_and_b32 s49, s49, 31
    s_add_u32 m0, s36, 67456
    v_mfma_f32_16x16x32_bf16 a[76:79], a[160:163], a[140:143], 0
    buffer_load_dwordx4 v9, s[8:11], s29 offen offset:128  lds
    v_mfma_f32_16x16x32_bf16 a[80:83], a[180:183], a[112:115], 0
    s_mul_i32 s29, s49, s32
    s_add_u32 m0, s36, 68608
    v_mfma_f32_16x16x32_bf16 a[84:87], a[180:183], a[116:119], 0
    buffer_load_dwordx4 v10, s[12:15], s30 offen offset:0  lds
    v_mfma_f32_16x16x32_bf16 a[88:91], a[180:183], a[120:123], 0
    s_mul_i32 s30, s49, s33
    s_add_u32 m0, s36, 69632
    v_mfma_f32_16x16x32_bf16 a[92:95], a[180:183], a[124:127], 0
    buffer_load_dwordx4 v11, s[16:19], s31 offen offset:0  lds
    v_mfma_f32_16x16x32_bf16 a[96:99], a[180:183], a[128:131], 0
    s_mul_i32 s31, s49, s34
    buffer_load_dword v17, v16, s[24:27], s43 offen
    v_mfma_f32_16x16x32_bf16 a[100:103], a[180:183], a[132:135], 0
    s_add_u32 s3, s3, 1
    v_mfma_f32_16x16x32_bf16 a[104:107], a[180:183], a[136:139], 0
    s_and_b32 s3, s3, 15
    s_mul_i32 s43, s3, s44
    v_mfma_f32_16x16x32_bf16 a[108:111], a[180:183], a[140:143], 0
    s_waitcnt vmcnt(11) lgkmcnt(0)
    s_barrier
    v_mfma_f32_16x16x32_bf16 v[48:51], a[216:219], a[184:187], v[48:51]
    ds_read_b64_tr_b16 a[144:145], v15 offset:0
    v_mfma_f32_16x16x32_bf16 v[52:55], a[216:219], a[188:191], v[52:55]
    s_add_u32 m0, s35, 0
    v_mfma_f32_16x16x32_bf16 v[56:59], a[216:219], a[192:195], v[56:59]
    ds_read_b64_tr_b16 a[146:147], v15 offset:256
    v_mfma_f32_16x16x32_bf16 v[60:63], a[216:219], a[196:199], v[60:63]
    buffer_load_dwordx4 v1, s[4:7], s28 offen  lds
    v_mfma_f32_16x16x32_bf16 v[64:67], a[216:219], a[200:203], v[64:67]
    ds_read_b128 a[112:115], v12 offset:32768
    v_mfma_f32_16x16x32_bf16 v[68:71], a[216:219], a[204:207], v[68:71]
    v_mfma_f32_16x16x32_bf16 v[72:75], a[216:219], a[208:211], v[72:75]
    ds_read_b128 a[116:119], v12 offset:34816
    v_mfma_f32_16x16x32_bf16 v[76:79], a[216:219], a[212:215], v[76:79]
    s_add_u32 m0, s35, 1024
    v_mfma_f32_16x16x32_bf16 v[80:83], a[236:239], a[184:187], v[80:83]
    ds_read_b128 a[120:123], v12 offset:36864
    v_mfma_f32_16x16x32_bf16 v[84:87], a[236:239], a[188:191], v[84:87]
    v_mfma_f32_16x16x32_bf16 v[88:91], a[236:239], a[192:195], v[88:91]
    ds_read_b128 a[124:127], v12 offset:38912
    v_mfma_f32_16x16x32_bf16 v[92:95], a[236:239], a[196:199], v[92:95]
    buffer_load_dwordx4 v2, s[4:7], s28 offen  lds
    v_mfma_f32_16x16x32_bf16 v[96:99], a[236:239], a[200:203], v[96:99]
    ds_read_b128 a[128:131], v12 offset:40960
    v_mfma_f32_16x16x32_bf16 v[100:103], a[236:239], a[204:207], v[100:103]
    v_mfma_f32_16x16x32_bf16 v[104:107], a[236:239], a[208:211], v[104:107]
    ds_read_b128 a[132:135], v12 offset:43008
    v_mfma_f32_16x16x32_bf16 v[108:111], a[236:239], a[212:215], v[108:111]
    s_add_u32 m0, s35, 2048
    v_mfma_f32_16x16x32_bf16 v[112:115], a[220:223], a[184:187], v[112:115]
    ds_read_b128 a[136:139], v12 offset:45056
    v_mfma_f32_16x16x32_bf16 v[116:119], a[220:223], a[188:191], v[116:119]
    v_mfma_f32_16x16x32_bf16 v[120:123], a[220:223], a[192:195], v[120:123]
    ds_read_b128 a[140:143], v12 offset:47104
    v_mfma_f32_16x16x32_bf16 v[124:127], a[220:223], a[196:199], v[124:127]
    buffer_load_dwordx4 v3, s[4:7], s28 offen  lds
    v_mfma_f32_16x16x32_bf16 v[128:131], a[220:223], a[200:203], v[128:131]
    ds_read_b64_tr_b16 a[164:165], v15 offset:5120
    v_mfma_f32_16x16x32_bf16 v[132:135], a[220:223], a[204:207], v[132:135]
    s_add_u32 m0, s35, 3072
    v_mfma_f32_16x16x32_bf16 v[136:139], a[220:223], a[208:211], v[136:139]
    ds_read_b64_tr_b16 a[166:167], v15 offset:5376
    v_mfma_f32_16x16x32_bf16 v[140:143], a[220:223], a[212:215], v[140:143]
    v_mfma_f32_16x16x32_bf16 v[144:147], a[240:243], a[184:187], v[144:147]
    ds_read_b64_tr_b16 a[148:149], v15 offset:1024
    v_mfma_f32_16x16x32_bf16 v[148:151], a[240:243], a[188:191], v[148:151]
    buffer_load_dwordx4 v4, s[4:7], s28 offen  lds
    v_mfma_f32_16x16x32_bf16 v[152:155], a[240:243], a[192:195], v[152:155]
    ds_read_b64_tr_b16 a[150:151], v15 offset:1280
    v_mfma_f32_16x16x32_bf16 v[156:159], a[240:243], a[196:199], v[156:159]
    v_mfma_f32_16x16x32_bf16 v[160:163], a[240:243], a[200:203], v[160:163]
    ds_read_b64_tr_b16 a[168:169], v15 offset:6144
    v_mfma_f32_16x16x32_bf16 v[164:167], a[240:243], a[204:207], v[164:167]
    s_add_u32 m0, s35, 4096
    v_mfma_f32_16x16x32_bf16 v[168:171], a[240:243], a[208:211], v[168:171]
    ds_read_b64_tr_b16 a[170:171], v15 offset:6400
    v_mfma_f32_16x16x32_bf16 v[172:175], a[240:243], a[212:215], v[172:175]
    v_mfma_f32_16x16x32_bf16 v[176:179], a[224:227], a[184:187], v[176:179]
    ds_read_b64_tr_b16 a[152:153], v15 offset:2048
    v_mfma_f32_16x16x32_bf16 v[180:183], a[224:227], a[188:191], v[180:183]
    buffer_load_dwordx4 v5, s[4:7], s28 offen  lds
    v_mfma_f32_16x16x32_bf16 v[184:187], a[224:227], a[192:195], v[184:187]
    ds_read_b64_tr_b16 a[154:155], v15 offset:2304
    v_mfma_f32_16x16x32_bf16 v[188:191], a[224:227], a[196:199], v[188:191]
    v_mfma_f32_16x16x32_bf16 v[192:195], a[224:227], a[200:203], v[192:195]
    ds_read_b64_tr_b16 a[172:173], v15 offset:7168
    v_mfma_f32_16x16x32_bf16 v[196:199], a[224:227], a[204:207], v[196:199]
    s_add_u32 m0, s35, 5120
    v_mfma_f32_16x16x32_bf16 v[200:203], a[224:227], a[208:211], v[200:203]
    ds_read_b64_tr_b16 a[174:175], v15 offset:7424
    v_mfma_f32_16x16x32_bf16 v[204:207], a[224:227], a[212:215], v[204:207]
    v_mfma_f32_16x16x32_bf16 v[208:211], a[244:247], a[184:187], v[208:211]
    ds_read_b64_tr_b16 a[156:157], v15 offset:3072
    v_mfma_f32_16x16x32_bf16 v[212:215], a[244:247], a[188:191], v[212:215]
    buffer_load_dwordx4 v6, s[4:7], s28 offen  lds
    v_mfma_f32_16x16x32_bf16 v[216:219], a[244:247], a[192:195], v[216:219]
    ds_read_b64_tr_b16 a[158:159], v15 offset:3328
    v_mfma_f32_16x16x32_bf16 v[220:223], a[244:247], a[196:199], v[220:223]
    s_add_u32 m0, s35, 6144
    v_mfma_f32_16x16x32_bf16 v[224:227], a[244:247], a[200:203], v[224:227]
    ds_read_b64_tr_b16 a[176:177], v15 offset:8192
    v_mfma_f32_16x16x32_bf16 v[228:231], a[244:247], a[204:207], v[228:231]
    v_mfma_f32_16x16x32_bf16 v[232:235], a[244:247], a[208:211], v[232:235]
    ds_read_b64_tr_b16 a[178:179], v15 offset:8448
    v_mfma_f32_16x16x32_bf16 v[236:239], a[244:247], a[212:215], v[236:239]
    buffer_load_dwordx4 v7, s[4:7], s28 offen  lds
    v_mfma_f32_16x16x32_bf16 v[240:243], a[228:231], a[184:187], v[240:243]
    ds_read_b64_tr_b16 a[160:161], v15 offset:4096
    v_mfma_f32_16x16x32_bf16 v[244:247], a[228:231], a[188:191], v[244:247]
    v_mfma_f32_16x16x32_bf16 v[248:251], a[228:231], a[192:195], v[248:251]
    ds_read_b64_tr_b16 a[162:163], v15 offset:4352
    v_mfma_f32_16x16x32_bf16 v[252:255], a[228:231], a[196:199], v[252:255]
    s_add_u32 m0, s35, 7168
    v_mfma_f32_16x16x32_bf16 a[0:3], a[228:231], a[200:203], a[0:3]
    ds_read_b64_tr_b16 a[180:181], v15 offset:9216
    v_mfma_f32_16x16x32_bf16 a[4:7], a[228:231], a[204:207], a[4:7]
    v_mfma_f32_16x16x32_bf16 a[8:11], a[228:231], a[208:211], a[8:11]
    ds_read_b64_tr_b16 a[182:183], v15 offset:9472
    v_mfma_f32_16x16x32_bf16 a[12:15], a[228:231], a[212:215], a[12:15]
    buffer_load_dwordx4 v8, s[4:7], s28 offen  lds
    v_mfma_f32_16x16x32_bf16 a[16:19], a[248:251], a[184:187], a[16:19]
    v_mfma_f32_16x16x32_bf16 a[20:23], a[248:251], a[188:191], a[20:23]
    s_add_u32 s28, s28, 128
    v_mfma_f32_16x16x32_bf16 a[24:27], a[248:251], a[192:195], a[24:27]
    s_and_b32 s28, s28, 2047
    v_mfma_f32_16x16x32_bf16 a[28:31], a[248:251], a[196:199], a[28:31]
    v_mfma_f32_16x16x32_bf16 a[32:35], a[248:251], a[200:203], a[32:35]
    buffer_load_dwordx4 v[28:31], v18, s[4:7], s59 offen
    v_mfma_f32_16x16x32_bf16 a[36:39], a[248:251], a[204:207], a[36:39]
    v_mfma_f32_16x16x32_bf16 a[40:43], a[248:251], a[208:211], a[40:43]
    buffer_load_dwordx4 v[32:35], v18, s[4:7], s59 offen offset:1024
    v_mfma_f32_16x16x32_bf16 a[44:47], a[248:251], a[212:215], a[44:47]
    v_mfma_f32_16x16x32_bf16 a[48:51], a[232:235], a[184:187], a[48:51]
    buffer_load_dwordx4 v[36:39], v18, s[4:7], s59 offen offset:2048
    v_mfma_f32_16x16x32_bf16 a[52:55], a[232:235], a[188:191], a[52:55]
    v_mfma_f32_16x16x32_bf16 a[56:59], a[232:235], a[192:195], a[56:59]
    buffer_load_dwordx4 v[40:43], v18, s[4:7], s59 offen offset:3072
    v_mfma_f32_16x16x32_bf16 a[60:63], a[232:235], a[196:199], a[60:63]
    v_mfma_f32_16x16x32_bf16 a[64:67], a[232:235], a[200:203], a[64:67]
    buffer_load_dwordx4 v[20:23], v18, s[80:83], 0 offen
    v_mfma_f32_16x16x32_bf16 a[68:71], a[232:235], a[204:207], a[68:71]
    buffer_load_dwordx4 v[24:27], v18, s[80:83], 0 offen offset:1024
    v_mfma_f32_16x16x32_bf16 a[72:75], a[232:235], a[208:211], a[72:75]
    v_mfma_f32_16x16x32_bf16 a[76:79], a[232:235], a[212:215], a[76:79]
    buffer_load_dword v17, v16, s[24:27], s43 offen
    v_mfma_f32_16x16x32_bf16 a[80:83], a[252:255], a[184:187], a[80:83]
    v_mfma_f32_16x16x32_bf16 a[84:87], a[252:255], a[188:191], a[84:87]
    s_add_u32 s3, s3, 1
    v_mfma_f32_16x16x32_bf16 a[88:91], a[252:255], a[192:195], a[88:91]
    v_mfma_f32_16x16x32_bf16 a[92:95], a[252:255], a[196:199], a[92:95]
    s_and_b32 s3, s3, 15
    v_mfma_f32_16x16x32_bf16 a[96:99], a[252:255], a[200:203], a[96:99]
    v_mfma_f32_16x16x32_bf16 a[100:103], a[252:255], a[204:207], a[100:103]
    s_mul_i32 s43, s3, s44
    v_mfma_f32_16x16x32_bf16 a[104:107], a[252:255], a[208:211], a[104:107]
    v_mfma_f32_16x16x32_bf16 a[108:111], a[252:255], a[212:215], a[108:111]
    s_waitcnt vmcnt(21) lgkmcnt(0)
    s_barrier
    v_mfma_f32_16x16x32_bf16 v[48:51], a[144:147], a[112:115], v[48:51]
    ds_read_b64_tr_b16 a[216:217], v15 offset:20480
    v_mfma_f32_16x16x32_bf16 v[52:55], a[144:147], a[116:119], v[52:55]
    s_add_u32 m0, s36, 86016
    v_mfma_f32_16x16x32_bf16 v[56:59], a[144:147], a[120:123], v[56:59]
    ds_read_b64_tr_b16 a[218:219], v15 offset:20736
    v_mfma_f32_16x16x32_bf16 v[60:63], a[144:147], a[124:127], v[60:63]
    buffer_load_dwordx4 v9, s[8:11], s29 offen offset:0  lds
    v_mfma_f32_16x16x32_bf16 v[64:67], a[144:147], a[128:131], v[64:67]
    ds_read_b128 a[184:187], v13 offset:32768
    v_mfma_f32_16x16x32_bf16 v[68:71], a[144:147], a[132:135], v[68:71]
    v_mfma_f32_16x16x32_bf16 v[72:75], a[144:147], a[136:139], v[72:75]
    ds_read_b128 a[188:191], v13 offset:34816
    v_mfma_f32_16x16x32_bf16 v[76:79], a[144:147], a[140:143], v[76:79]
    s_add_u32 s49, s49, 1
    v_mfma_f32_16x16x32_bf16 v[80:83], a[164:167], a[112:115], v[80:83]
    ds_read_b128 a[192:195], v13 offset:36864
    v_mfma_f32_16x16x32_bf16 v[84:87], a[164:167], a[116:119], v[84:87]
    s_add_u32 m0, s36, 86976
    v_mfma_f32_16x16x32_bf16 v[88:91], a[164:167], a[120:123], v[88:91]
    ds_read_b128 a[196:199], v13 offset:38912
    v_mfma_f32_16x16x32_bf16 v[92:95], a[164:167], a[124:127], v[92:95]
    v_mfma_f32_16x16x32_bf16 v[96:99], a[164:167], a[128:131], v[96:99]
    ds_read_b128 a[200:203], v13 offset:40960
    v_mfma_f32_16x16x32_bf16 v[100:103], a[164:167], a[132:135], v[100:103]
    buffer_load_dwordx4 v9, s[8:11], s29 offen offset:64  lds
    v_mfma_f32_16x16x32_bf16 v[104:107], a[164:167], a[136:139], v[104:107]
    ds_read_b128 a[204:207], v13 offset:43008
    v_mfma_f32_16x16x32_bf16 v[108:111], a[164:167], a[140:143], v[108:111]
    s_and_b32 s49, s49, 31
    v_mfma_f32_16x16x32_bf16 v[112:115], a[148:151], a[112:115], v[112:115]
    ds_read_b128 a[208:211], v13 offset:45056
    v_mfma_f32_16x16x32_bf16 v[116:119], a[148:151], a[116:119], v[116:119]
    v_mfma_f32_16x16x32_bf16 v[120:123], a[148:151], a[120:123], v[120:123]
    ds_read_b128 a[212:215], v13 offset:47104
    v_mfma_f32_16x16x32_bf16 v[124:127], a[148:151], a[124:127], v[124:127]
    s_add_u32 m0, s36, 87936
    v_mfma_f32_16x16x32_bf16 v[128:131], a[148:151], a[128:131], v[128:131]
    ds_read_b64_tr_b16 a[236:237], v15 offset:25600
    v_mfma_f32_16x16x32_bf16 v[132:135], a[148:151], a[132:135], v[132:135]
    buffer_load_dwordx4 v9, s[8:11], s29 offen offset:128  lds
    v_mfma_f32_16x16x32_bf16 v[136:139], a[148:151], a[136:139], v[136:139]
    ds_read_b64_tr_b16 a[238:239], v15 offset:25856
    v_mfma_f32_16x16x32_bf16 v[140:143], a[148:151], a[140:143], v[140:143]
    v_mfma_f32_16x16x32_bf16 v[144:147], a[168:171], a[112:115], v[144:147]
    ds_read_b64_tr_b16 a[220:221], v15 offset:21504
    v_mfma_f32_16x16x32_bf16 v[148:151], a[168:171], a[116:119], v[148:151]
    s_mul_i32 s29, s49, s32
    v_mfma_f32_16x16x32_bf16 v[152:155], a[168:171], a[120:123], v[152:155]
    ds_read_b64_tr_b16 a[222:223], v15 offset:21760
    v_mfma_f32_16x16x32_bf16 v[156:159], a[168:171], a[124:127], v[156:159]
    s_add_u32 m0, s36, 89088
    v_mfma_f32_16x16x32_bf16 v[160:163], a[168:171], a[128:131], v[160:163]
    ds_read_b64_tr_b16 a[240:241], v15 offset:26624
    v_mfma_f32_16x16x32_bf16 v[164:167], a[168:171], a[132:135], v[164:167]
    v_mfma_f32_16x16x32_bf16 v[168:171], a[168:171], a[136:139], v[168:171]
    ds_read_b64_tr_b16 a[242:243], v15 offset:26880
    v_mfma_f32_16x16x32_bf16 v[172:175], a[168:171], a[140:143], v[172:175]
    buffer_load_dwordx4 v10, s[12:15], s30 offen offset:0  lds
    v_mfma_f32_16x16x32_bf16 v[176:179], a[152:155], a[112:115], v[176:179]
    ds_read_b64_tr_b16 a[224:225], v15 offset:22528
    v_mfma_f32_16x16x32_bf16 v[180:183], a[152:155], a[116:119], v[180:183]
    s_mul_i32 s30, s49, s33
    v_mfma_f32_16x16x32_bf16 v[184:187], a[152:155], a[120:123], v[184:187]
    ds_read_b64_tr_b16 a[226:227], v15 offset:22784
    v_mfma_f32_16x16x32_bf16 v[188:191], a[152:155], a[124:127], v[188:191]
    v_mfma_f32_16x16x32_bf16 v[192:195], a[152:155], a[128:131], v[192:195]
    ds_read_b64_tr_b16 a[244:245], v15 offset:27648
    v_mfma_f32_16x16x32_bf16 v[196:199], a[152:155], a[132:135], v[196:199]
    s_add_u32 m0, s36, 90112
    v_mfma_f32_16x16x32_bf16 v[200:203], a[152:155], a[136:139], v[200:203]
    ds_read_b64_tr_b16 a[246:247], v15 offset:27904
    v_mfma_f32_16x16x32_bf16 v[204:207], a[152:155], a[140:143], v[204:207]
    buffer_load_dwordx4 v11, s[16:19], s31 offen offset:0  lds
    v_mfma_f32_16x16x32_bf16 v[208:211], a[172:175], a[112:115], v[208:211]
    ds_read_b64_tr_b16 a[228:229], v15 offset:23552
    v_mfma_f32_16x16x32_bf16 v[212:215], a[172:175], a[116:119], v[212:215]
    v_mfma_f32_16x16x32_bf16 v[216:219], a[172:175], a[120:123], v[216:219]
    ds_read_b64_tr_b16 a[230:231], v15 offset:23808
    v_mfma_f32_16x16x32_bf16 v[220:223], a[172:175], a[124:127], v[220:223]
    s_mul_i32 s31, s49, s34
    v_mfma_f32_16x16x32_bf16 v[224:227], a[172:175], a[128:131], v[224:227]
    ds_read_b64_tr_b16 a[248:249], v15 offset:28672
    v_mfma_f32_16x16x32_bf16 v[228:231], a[172:175], a[132:135], v[228:231]
    s_add_u32 m0, s36, 106496
    v_mfma_f32_16x16x32_bf16 v[232:235], a[172:175], a[136:139], v[232:235]
    ds_read_b64_tr_b16 a[250:251], v15 offset:28928
    v_mfma_f32_16x16x32_bf16 v[236:239], a[172:175], a[140:143], v[236:239]
    v_mfma_f32_16x16x32_bf16 v[240:243], a[156:159], a[112:115], v[240:243]
    ds_read_b64_tr_b16 a[232:233], v15 offset:24576
    v_mfma_f32_16x16x32_bf16 v[244:247], a[156:159], a[116:119], v[244:247]
    buffer_load_dwordx4 v9, s[8:11], s29 offen offset:0  lds
    v_mfma_f32_16x16x32_bf16 v[248:251], a[156:159], a[120:123], v[248:251]
    ds_read_b64_tr_b16 a[234:235], v15 offset:24832
    v_mfma_f32_16x16x32_bf16 v[252:255], a[156:159], a[124:127], v[252:255]
    s_add_u32 s49, s49, 1
    v_mfma_f32_16x16x32_bf16 a[0:3], a[156:159], a[128:131], a[0:3]
    ds_read_b64_tr_b16 a[252:253], v15 offset:29696
    v_mfma_f32_16x16x32_bf16 a[4:7], a[156:159], a[132:135], a[4:7]
    v_mfma_f32_16x16x32_bf16 a[8:11], a[156:159], a[136:139], a[8:11]
    ds_read_b64_tr_b16 a[254:255], v15 offset:29952
    v_mfma_f32_16x16x32_bf16 a[12:15], a[156:159], a[140:143], a[12:15]
    s_add_u32 m0, s36, 107456
    v_mfma_f32_16x16x32_bf16 a[16:19], a[176:179], a[112:115], a[16:19]
    buffer_load_dwordx4 v9, s[8:11], s29 offen offset:64  lds
    v_mfma_f32_16x16x32_bf16 a[20:23], a[176:179], a[116:119], a[20:23]
    v_mfma_f32_16x16x32_bf16 a[24:27], a[176:179], a[120:123], a[24:27]
    s_and_b32 s49, s49, 31
    v_mfma_f32_16x16x32_bf16 a[28:31], a[176:179], a[124:127], a[28:31]
    s_add_u32 m0, s36, 108416
    v_mfma_f32_16x16x32_bf16 a[32:35], a[176:179], a[128:131], a[32:35]
    v_mfma_f32_16x16x32_bf16 a[36:39], a[176:179], a[132:135], a[36:39]
    buffer_load_dwordx4 v9, s[8:11], s29 offen offset:128  lds
    v_mfma_f32_16x16x32_bf16 a[40:43], a[176:179], a[136:139], a[40:43]
    s_mul_i32 s29, s49, s32
    v_mfma_f32_16x16x32_bf16 a[44:47], a[176:179], a[140:143], a[44:47]
    v_mfma_f32_16x16x32_bf16 a[48:51], a[160:163], a[112:115], a[48:51]
    s_add_u32 m0, s36, 109568
    v_mfma_f32_16x16x32_bf16 a[52:55], a[160:163], a[116:119], a[52:55]
    buffer_load_dwordx4 v10, s[12:15], s30 offen offset:0  lds
    v_mfma_f32_16x16x32_bf16 a[56:59], a[160:163], a[120:123], a[56:59]
    v_mfma_f32_16x16x32_bf16 a[60:63], a[160:163], a[124:127], a[60:63]
    s_mul_i32 s30, s49, s33
    v_mfma_f32_16x16x32_bf16 a[64:67], a[160:163], a[128:131], a[64:67]
    s_add_u32 m0, s36, 110592
    v_mfma_f32_16x16x32_bf16 a[68:71], a[160:163], a[132:135], a[68:71]
    v_mfma_f32_16x16x32_bf16 a[72:75], a[160:163], a[136:139], a[72:75]
    buffer_load_dwordx4 v11, s[16:19], s31 offen offset:0  lds
    v_mfma_f32_16x16x32_bf16 a[76:79], a[160:163], a[140:143], a[76:79]
    s_mul_i32 s31, s49, s34
    v_mfma_f32_16x16x32_bf16 a[80:83], a[180:183], a[112:115], a[80:83]
    v_mfma_f32_16x16x32_bf16 a[84:87], a[180:183], a[116:119], a[84:87]
    buffer_load_dword v17, v16, s[24:27], s43 offen
    v_mfma_f32_16x16x32_bf16 a[88:91], a[180:183], a[120:123], a[88:91]
    s_add_u32 s3, s3, 1
    v_mfma_f32_16x16x32_bf16 a[92:95], a[180:183], a[124:127], a[92:95]
    v_mfma_f32_16x16x32_bf16 a[96:99], a[180:183], a[128:131], a[96:99]
    s_and_b32 s3, s3, 15
    v_mfma_f32_16x16x32_bf16 a[100:103], a[180:183], a[132:135], a[100:103]
    s_mul_i32 s43, s3, s44
    v_mfma_f32_16x16x32_bf16 a[104:107], a[180:183], a[136:139], a[104:107]
    v_mfma_f32_16x16x32_bf16 a[108:111], a[180:183], a[140:143], a[108:111]
    s_waitcnt vmcnt(12) lgkmcnt(0)
    s_barrier
    v_mfma_f32_16x16x32_bf16 v[48:51], a[216:219], a[184:187], v[48:51]
    ds_read_b64_tr_b16 a[144:145], v14 offset:0
    v_mfma_f32_16x16x32_bf16 v[52:55], a[216:219], a[188:191], v[52:55]
    s_add_u32 m0, s35, 32768
    v_mfma_f32_16x16x32_bf16 v[56:59], a[216:219], a[192:195], v[56:59]
    ds_read_b64_tr_b16 a[146:147], v14 offset:256
    v_mfma_f32_16x16x32_bf16 v[60:63], a[216:219], a[196:199], v[60:63]
    v_mov_b32 v44, 0
    v_mfma_f32_16x16x32_bf16 v[64:67], a[216:219], a[200:203], v[64:67]
    ds_read_b128 a[112:115], v12 offset:0
    v_mfma_f32_16x16x32_bf16 v[68:71], a[216:219], a[204:207], v[68:71]
    v_mov_b32 v45, 0
    v_mfma_f32_16x16x32_bf16 v[72:75], a[216:219], a[208:211], v[72:75]
    ds_read_b128 a[116:119], v12 offset:2048
    v_mfma_f32_16x16x32_bf16 v[76:79], a[216:219], a[212:215], v[76:79]
    v_dot2_f32_bf16 v44, v28, v20, v44
    v_mfma_f32_16x16x32_bf16 v[80:83], a[236:239], a[184:187], v[80:83]
    ds_read_b128 a[120:123], v12 offset:4096
    v_mfma_f32_16x16x32_bf16 v[84:87], a[236:239], a[188:191], v[84:87]
    buffer_load_dwordx4 v1, s[4:7], s28 offen  lds
    v_mfma_f32_16x16x32_bf16 v[88:91], a[236:239], a[192:195], v[88:91]
    ds_read_b128 a[124:127], v12 offset:6144
    v_mfma_f32_16x16x32_bf16 v[92:95], a[236:239], a[196:199], v[92:95]
    v_dot2_f32_bf16 v45, v36, v20, v45
    v_mfma_f32_16x16x32_bf16 v[96:99], a[236:239], a[200:203], v[96:99]
    ds_read_b128 a[128:131], v12 offset:8192
    v_mfma_f32_16x16x32_bf16 v[100:103], a[236:239], a[204:207], v[100:103]
    v_dot2_f32_bf16 v44, v29, v21, v44
    v_mfma_f32_16x16x32_bf16 v[104:107], a[236:239], a[208:211], v[104:107]
    ds_read_b128 a[132:135], v12 offset:10240
    v_mfma_f32_16x16x32_bf16 v[108:111], a[236:239], a[212:215], v[108:111]
    s_add_u32 m0, s35, 33792
    v_mfma_f32_16x16x32_bf16 v[112:115], a[220:223], a[184:187], v[112:115]
    ds_read_b128 a[136:139], v12 offset:12288
    v_mfma_f32_16x16x32_bf16 v[116:119], a[220:223], a[188:191], v[116:119]
    v_dot2_f32_bf16 v45, v37, v21, v45
    v_mfma_f32_16x16x32_bf16 v[120:123], a[220:223], a[192:195], v[120:123]
    ds_read_b128 a[140:143], v12 offset:14336
    v_mfma_f32_16x16x32_bf16 v[124:127], a[220:223], a[196:199], v[124:127]
    v_dot2_f32_bf16 v44, v30, v22, v44
    v_mfma_f32_16x16x32_bf16 v[128:131], a[220:223], a[200:203], v[128:131]
    ds_read_b64_tr_b16 a[164:165], v14 offset:5120
    v_mfma_f32_16x16x32_bf16 v[132:135], a[220:223], a[204:207], v[132:135]
    v_dot2_f32_bf16 v45, v38, v22, v45
    v_mfma_f32_16x16x32_bf16 v[136:139], a[220:223], a[208:211], v[136:139]
    ds_read_b64_tr_b16 a[166:167], v14 offset:5376
    v_mfma_f32_16x16x32_bf16 v[140:143], a[220:223], a[212:215], v[140:143]
    buffer_load_dwordx4 v2, s[4:7], s28 offen  lds
    v_mfma_f32_16x16x32_bf16 v[144:147], a[240:243], a[184:187], v[144:147]
    ds_read_b64_tr_b16 a[148:149], v14 offset:1024
    v_mfma_f32_16x16x32_bf16 v[148:151], a[240:243], a[188:191], v[148:151]
    v_dot2_f32_bf16 v44, v31, v23, v44
    v_mfma_f32_16x16x32_bf16 v[152:155], a[240:243], a[192:195], v[152:155]
    ds_read_b64_tr_b16 a[150:151], v14 offset:1280
    v_mfma_f32_16x16x32_bf16 v[156:159], a[240:243], a[196:199], v[156:159]
    v_dot2_f32_bf16 v45, v39, v23, v45
    v_mfma_f32_16x16x32_bf16 v[160:163], a[240:243], a[200:203], v[160:163]
    ds_read_b64_tr_b16 a[168:169], v14 offset:6144
    v_mfma_f32_16x16x32_bf16 v[164:167], a[240:243], a[204:207], v[164:167]
    s_add_u32 m0, s35, 34816
    v_mfma_f32_16x16x32_bf16 v[168:171], a[240:243], a[208:211], v[168:171]
    ds_read_b64_tr_b16 a[170:171], v14 offset:6400
    v_mfma_f32_16x16x32_bf16 v[172:175], a[240:243], a[212:215], v[172:175]
    v_dot2_f32_bf16 v44, v32, v24, v44
    v_mfma_f32_16x16x32_bf16 v[176:179], a[224:227], a[184:187], v[176:179]
    ds_read_b64_tr_b16 a[152:153], v14 offset:2048
    v_mfma_f32_16x16x32_bf16 v[180:183], a[224:227], a[188:191], v[180:183]
    v_dot2_f32_bf16 v45, v40, v24, v45
    v_mfma_f32_16x16x32_bf16 v[184:187], a[224:227], a[192:195], v[184:187]
    ds_read_b64_tr_b16 a[154:155], v14 offset:2304
    v_mfma_f32_16x16x32_bf16 v[188:191], a[224:227], a[196:199], v[188:191]
    v_dot2_f32_bf16 v44, v33, v25, v44
    v_mfma_f32_16x16x32_bf16 v[192:195], a[224:227], a[200:203], v[192:195]
    ds_read_b64_tr_b16 a[172:173], v14 offset:7168
    v_mfma_f32_16x16x32_bf16 v[196:199], a[224:227], a[204:207], v[196:199]
    buffer_load_dwordx4 v3, s[4:7], s28 offen  lds
    v_mfma_f32_16x16x32_bf16 v[200:203], a[224:227], a[208:211], v[200:203]
    ds_read_b64_tr_b16 a[174:175], v14 offset:7424
    v_mfma_f32_16x16x32_bf16 v[204:207], a[224:227], a[212:215], v[204:207]
    v_dot2_f32_bf16 v45, v41, v25, v45
    v_mfma_f32_16x16x32_bf16 v[208:211], a[244:247], a[184:187], v[208:211]
    ds_read_b64_tr_b16 a[156:157], v14 offset:3072
    v_mfma_f32_16x16x32_bf16 v[212:215], a[244:247], a[188:191], v[212:215]
    v_dot2_f32_bf16 v44, v34, v26, v44
    v_mfma_f32_16x16x32_bf16 v[216:219], a[244:247], a[192:195], v[216:219]
    ds_read_b64_tr_b16 a[158:159], v14 offset:3328
    v_mfma_f32_16x16x32_bf16 v[220:223], a[244:247], a[196:199], v[220:223]
    s_add_u32 m0, s35, 35840
    v_mfma_f32_16x16x32_bf16 v[224:227], a[244:247], a[200:203], v[224:227]
    ds_read_b64_tr_b16 a[176:177], v14 offset:8192
    v_mfma_f32_16x16x32_bf16 v[228:231], a[244:247], a[204:207], v[228:231]
    v_dot2_f32_bf16 v45, v42, v26, v45
    v_mfma_f32_16x16x32_bf16 v[232:235], a[244:247], a[208:211], v[232:235]
    ds_read_b64_tr_b16 a[178:179], v14 offset:8448
    v_mfma_f32_16x16x32_bf16 v[236:239], a[244:247], a[212:215], v[236:239]
    v_dot2_f32_bf16 v44, v35, v27, v44
    v_mfma_f32_16x16x32_bf16 v[240:243], a[228:231], a[184:187], v[240:243]
    ds_read_b64_tr_b16 a[160:161], v14 offset:4096
    v_mfma_f32_16x16x32_bf16 v[244:247], a[228:231], a[188:191], v[244:247]
    v_dot2_f32_bf16 v45, v43, v27, v45
    v_mfma_f32_16x16x32_bf16 v[248:251], a[228:231], a[192:195], v[248:251]
    ds_read_b64_tr_b16 a[162:163], v14 offset:4352
    v_mfma_f32_16x16x32_bf16 v[252:255], a[228:231], a[196:199], v[252:255]
    buffer_load_dwordx4 v4, s[4:7], s28 offen  lds
    v_mfma_f32_16x16x32_bf16 a[0:3], a[228:231], a[200:203], a[0:3]
    ds_read_b64_tr_b16 a[180:181], v14 offset:9216
    v_mfma_f32_16x16x32_bf16 a[4:7], a[228:231], a[204:207], a[4:7]
    v_add_f32_dpp v44, v44, v44 quad_perm:[1,0,3,2] row_mask:0xf bank_mask:0xf
    v_mfma_f32_16x16x32_bf16 a[8:11], a[228:231], a[208:211], a[8:11]
    ds_read_b64_tr_b16 a[182:183], v14 offset:9472
    v_mfma_f32_16x16x32_bf16 a[12:15], a[228:231], a[212:215], a[12:15]
    v_add_f32_dpp v45, v45, v45 quad_perm:[1,0,3,2] row_mask:0xf bank_mask:0xf
    v_mfma_f32_16x16x32_bf16 a[16:19], a[248:251], a[184:187], a[16:19]
    s_add_u32 m0, s35, 36864
    v_mfma_f32_16x16x32_bf16 a[20:23], a[248:251], a[188:191], a[20:23]
    v_add_f32_dpp v44, v44, v44 quad_perm:[2,3,0,1] row_mask:0xf bank_mask:0xf
    v_mfma_f32_16x16x32_bf16 a[24:27], a[248:251], a[192:195], a[24:27]
    v_add_f32_dpp v45, v45, v45 quad_perm:[2,3,0,1] row_mask:0xf bank_mask:0xf
    v_mfma_f32_16x16x32_bf16 a[28:31], a[248:251], a[196:199], a[28:31]
    buffer_load_dwordx4 v5, s[4:7], s28 offen  lds
    v_mfma_f32_16x16x32_bf16 a[32:35], a[248:251], a[200:203], a[32:35]
    v_add_f32_dpp v44, v44, v44 row_half_mirror row_mask:0xf bank_mask:0xf
    v_mfma_f32_16x16x32_bf16 a[36:39], a[248:251], a[204:207], a[36:39]
    v_add_f32_dpp v45, v45, v45 row_half_mirror row_mask:0xf bank_mask:0xf
    v_mfma_f32_16x16x32_bf16 a[40:43], a[248:251], a[208:211], a[40:43]
    v_add_f32_dpp v44, v44, v44 row_mirror row_mask:0xf bank_mask:0xf
    v_mfma_f32_16x16x32_bf16 a[44:47], a[248:251], a[212:215], a[44:47]
    s_add_u32 m0, s35, 37888
    v_mfma_f32_16x16x32_bf16 a[48:51], a[232:235], a[184:187], a[48:51]
    v_add_f32_dpp v45, v45, v45 row_mirror row_mask:0xf bank_mask:0xf
    v_mfma_f32_16x16x32_bf16 a[52:55], a[232:235], a[188:191], a[52:55]
    v_add_f32_dpp v44, v44, v44 row_bcast:15 row_mask:0xa bank_mask:0xf
    v_mfma_f32_16x16x32_bf16 a[56:59], a[232:235], a[192:195], a[56:59]
    buffer_load_dwordx4 v6, s[4:7], s28 offen  lds
    v_mfma_f32_16x16x32_bf16 a[60:63], a[232:235], a[196:199], a[60:63]
    v_add_f32_dpp v45, v45, v45 row_bcast:15 row_mask:0xa bank_mask:0xf
    v_mfma_f32_16x16x32_bf16 a[64:67], a[232:235], a[200:203], a[64:67]
    v_add_f32_dpp v44, v44, v44 row_bcast:31 row_mask:0xc bank_mask:0xf
    v_add_f32_dpp v45, v45, v45 row_bcast:31 row_mask:0xc bank_mask:0xf
    v_mfma_f32_16x16x32_bf16 a[68:71], a[232:235], a[204:207], a[68:71]
    s_add_u32 m0, s35, 38912
    v_mul_f32 v44, 0xbfb8aa3b, v44
    v_mfma_f32_16x16x32_bf16 a[72:75], a[232:235], a[208:211], a[72:75]
    v_mul_f32 v45, 0xbfb8aa3b, v45
    buffer_load_dwordx4 v7, s[4:7], s28 offen  lds
    v_mfma_f32_16x16x32_bf16 a[76:79], a[232:235], a[212:215], a[76:79]
    v_exp_f32 v44, v44
    v_exp_f32 v45, v45
    v_mfma_f32_16x16x32_bf16 a[80:83], a[252:255], a[184:187], a[80:83]
    v_add_f32 v44, 1.0, v44
    s_add_u32 m0, s35, 39936
    v_mfma_f32_16x16x32_bf16 a[84:87], a[252:255], a[188:191], a[84:87]
    v_add_f32 v45, 1.0, v45
    v_rcp_f32 v46, v44
    v_mfma_f32_16x16x32_bf16 a[88:91], a[252:255], a[192:195], a[88:91]
    buffer_load_dwordx4 v8, s[4:7], s28 offen  lds
    v_rcp_f32 v47, v45
    v_mfma_f32_16x16x32_bf16 a[92:95], a[252:255], a[196:199], a[92:95]
    v_mov_b32 v20, 0
    v_mov_b32 v21, 0
    v_mfma_f32_16x16x32_bf16 a[96:99], a[252:255], a[200:203], a[96:99]
    s_add_u32 s28, s28, 128
    v_mov_b32 v22, 0
    v_mfma_f32_16x16x32_bf16 a[100:103], a[252:255], a[204:207], a[100:103]
    v_mov_b32 v23, 0
    s_and_b32 s28, s28, 2047
    v_mfma_f32_16x16x32_bf16 a[104:107], a[252:255], a[208:211], a[104:107]
    s_lshl_b32 s57, s58, 11
    s_add_u32 s57, s57, 0x2400000
    v_mfma_f32_16x16x32_bf16 a[108:111], a[252:255], a[212:215], a[108:111]
k1_kernel_loop:
    s_waitcnt vmcnt(14) lgkmcnt(0)
    s_barrier
    v_mfma_f32_16x16x32_bf16 v[48:51], a[144:147], a[112:115], v[48:51]
    ds_read_b64_tr_b16 a[216:217], v14 offset:20480
    v_mfma_f32_16x16x32_bf16 v[52:55], a[144:147], a[116:119], v[52:55]
    s_add_u32 m0, s36, 126976
    v_mfma_f32_16x16x32_bf16 v[56:59], a[144:147], a[120:123], v[56:59]
    ds_read_b64_tr_b16 a[218:219], v14 offset:20736
    v_mfma_f32_16x16x32_bf16 v[60:63], a[144:147], a[124:127], v[60:63]
    buffer_load_dwordx4 v9, s[8:11], s29 offen offset:0  lds
    v_mfma_f32_16x16x32_bf16 v[64:67], a[144:147], a[128:131], v[64:67]
    ds_read_b128 a[184:187], v13 offset:0
    v_mfma_f32_16x16x32_bf16 v[68:71], a[144:147], a[132:135], v[68:71]
    v_mfma_f32_16x16x32_bf16 v[72:75], a[144:147], a[136:139], v[72:75]
    ds_read_b128 a[188:191], v13 offset:2048
    v_mfma_f32_16x16x32_bf16 v[76:79], a[144:147], a[140:143], v[76:79]
    s_add_u32 s49, s49, 1
    v_mfma_f32_16x16x32_bf16 v[80:83], a[164:167], a[112:115], v[80:83]
    ds_read_b128 a[192:195], v13 offset:4096
    v_mfma_f32_16x16x32_bf16 v[84:87], a[164:167], a[116:119], v[84:87]
    s_add_u32 m0, s36, 127936
    v_mfma_f32_16x16x32_bf16 v[88:91], a[164:167], a[120:123], v[88:91]
    ds_read_b128 a[196:199], v13 offset:6144
    v_mfma_f32_16x16x32_bf16 v[92:95], a[164:167], a[124:127], v[92:95]
    v_mfma_f32_16x16x32_bf16 v[96:99], a[164:167], a[128:131], v[96:99]
    ds_read_b128 a[200:203], v13 offset:8192
    v_mfma_f32_16x16x32_bf16 v[100:103], a[164:167], a[132:135], v[100:103]
    buffer_load_dwordx4 v9, s[8:11], s29 offen offset:64  lds
    v_mfma_f32_16x16x32_bf16 v[104:107], a[164:167], a[136:139], v[104:107]
    ds_read_b128 a[204:207], v13 offset:10240
    v_mfma_f32_16x16x32_bf16 v[108:111], a[164:167], a[140:143], v[108:111]
    s_and_b32 s49, s49, 31
    v_mfma_f32_16x16x32_bf16 v[112:115], a[148:151], a[112:115], v[112:115]
    ds_read_b128 a[208:211], v13 offset:12288
    v_mfma_f32_16x16x32_bf16 v[116:119], a[148:151], a[116:119], v[116:119]
    v_mfma_f32_16x16x32_bf16 v[120:123], a[148:151], a[120:123], v[120:123]
    ds_read_b128 a[212:215], v13 offset:14336
    v_mfma_f32_16x16x32_bf16 v[124:127], a[148:151], a[124:127], v[124:127]
    s_add_u32 m0, s36, 128896
    v_mfma_f32_16x16x32_bf16 v[128:131], a[148:151], a[128:131], v[128:131]
    ds_read_b64_tr_b16 a[236:237], v14 offset:25600
    v_mfma_f32_16x16x32_bf16 v[132:135], a[148:151], a[132:135], v[132:135]
    buffer_load_dwordx4 v9, s[8:11], s29 offen offset:128  lds
    v_mfma_f32_16x16x32_bf16 v[136:139], a[148:151], a[136:139], v[136:139]
    ds_read_b64_tr_b16 a[238:239], v14 offset:25856
    v_mfma_f32_16x16x32_bf16 v[140:143], a[148:151], a[140:143], v[140:143]
    v_mfma_f32_16x16x32_bf16 v[144:147], a[168:171], a[112:115], v[144:147]
    ds_read_b64_tr_b16 a[220:221], v14 offset:21504
    v_mfma_f32_16x16x32_bf16 v[148:151], a[168:171], a[116:119], v[148:151]
    s_mul_i32 s29, s49, s32
    v_mfma_f32_16x16x32_bf16 v[152:155], a[168:171], a[120:123], v[152:155]
    ds_read_b64_tr_b16 a[222:223], v14 offset:21760
    v_mfma_f32_16x16x32_bf16 v[156:159], a[168:171], a[124:127], v[156:159]
    s_add_u32 m0, s36, 130048
    v_mfma_f32_16x16x32_bf16 v[160:163], a[168:171], a[128:131], v[160:163]
    ds_read_b64_tr_b16 a[240:241], v14 offset:26624
    v_mfma_f32_16x16x32_bf16 v[164:167], a[168:171], a[132:135], v[164:167]
    v_mfma_f32_16x16x32_bf16 v[168:171], a[168:171], a[136:139], v[168:171]
    ds_read_b64_tr_b16 a[242:243], v14 offset:26880
    v_mfma_f32_16x16x32_bf16 v[172:175], a[168:171], a[140:143], v[172:175]
    buffer_load_dwordx4 v10, s[12:15], s30 offen offset:0  lds
    v_mfma_f32_16x16x32_bf16 v[176:179], a[152:155], a[112:115], v[176:179]
    ds_read_b64_tr_b16 a[224:225], v14 offset:22528
    v_mfma_f32_16x16x32_bf16 v[180:183], a[152:155], a[116:119], v[180:183]
    s_mul_i32 s30, s49, s33
    v_mfma_f32_16x16x32_bf16 v[184:187], a[152:155], a[120:123], v[184:187]
    ds_read_b64_tr_b16 a[226:227], v14 offset:22784
    v_mfma_f32_16x16x32_bf16 v[188:191], a[152:155], a[124:127], v[188:191]
    v_mfma_f32_16x16x32_bf16 v[192:195], a[152:155], a[128:131], v[192:195]
    ds_read_b64_tr_b16 a[244:245], v14 offset:27648
    v_mfma_f32_16x16x32_bf16 v[196:199], a[152:155], a[132:135], v[196:199]
    s_add_u32 m0, s36, 131072
    v_mfma_f32_16x16x32_bf16 v[200:203], a[152:155], a[136:139], v[200:203]
    ds_read_b64_tr_b16 a[246:247], v14 offset:27904
    v_mfma_f32_16x16x32_bf16 v[204:207], a[152:155], a[140:143], v[204:207]
    buffer_load_dwordx4 v11, s[16:19], s31 offen offset:0  lds
    v_mfma_f32_16x16x32_bf16 v[208:211], a[172:175], a[112:115], v[208:211]
    ds_read_b64_tr_b16 a[228:229], v14 offset:23552
    v_mfma_f32_16x16x32_bf16 v[212:215], a[172:175], a[116:119], v[212:215]
    v_mfma_f32_16x16x32_bf16 v[216:219], a[172:175], a[120:123], v[216:219]
    ds_read_b64_tr_b16 a[230:231], v14 offset:23808
    v_mfma_f32_16x16x32_bf16 v[220:223], a[172:175], a[124:127], v[220:223]
    s_mul_i32 s31, s49, s34
    v_mfma_f32_16x16x32_bf16 v[224:227], a[172:175], a[128:131], v[224:227]
    ds_read_b64_tr_b16 a[248:249], v14 offset:28672
    v_mfma_f32_16x16x32_bf16 v[228:231], a[172:175], a[132:135], v[228:231]
    s_add_u32 m0, s36, 65536
    v_mfma_f32_16x16x32_bf16 v[232:235], a[172:175], a[136:139], v[232:235]
    ds_read_b64_tr_b16 a[250:251], v14 offset:28928
    v_mfma_f32_16x16x32_bf16 v[236:239], a[172:175], a[140:143], v[236:239]
    v_mfma_f32_16x16x32_bf16 v[240:243], a[156:159], a[112:115], v[240:243]
    ds_read_b64_tr_b16 a[232:233], v14 offset:24576
    v_mfma_f32_16x16x32_bf16 v[244:247], a[156:159], a[116:119], v[244:247]
    buffer_load_dwordx4 v9, s[8:11], s29 offen offset:0  lds
    v_mfma_f32_16x16x32_bf16 v[248:251], a[156:159], a[120:123], v[248:251]
    ds_read_b64_tr_b16 a[234:235], v14 offset:24832
    v_mfma_f32_16x16x32_bf16 v[252:255], a[156:159], a[124:127], v[252:255]
    s_add_u32 s49, s49, 1
    v_mfma_f32_16x16x32_bf16 a[0:3], a[156:159], a[128:131], a[0:3]
    ds_read_b64_tr_b16 a[252:253], v14 offset:29696
    v_mfma_f32_16x16x32_bf16 a[4:7], a[156:159], a[132:135], a[4:7]
    v_mfma_f32_16x16x32_bf16 a[8:11], a[156:159], a[136:139], a[8:11]
    ds_read_b64_tr_b16 a[254:255], v14 offset:29952
    v_mfma_f32_16x16x32_bf16 a[12:15], a[156:159], a[140:143], a[12:15]
    s_add_u32 m0, s36, 66496
    v_mfma_f32_16x16x32_bf16 a[16:19], a[176:179], a[112:115], a[16:19]
    buffer_load_dwordx4 v9, s[8:11], s29 offen offset:64  lds
    v_mfma_f32_16x16x32_bf16 a[20:23], a[176:179], a[116:119], a[20:23]
    v_mfma_f32_16x16x32_bf16 a[24:27], a[176:179], a[120:123], a[24:27]
    s_and_b32 s49, s49, 31
    v_mfma_f32_16x16x32_bf16 a[28:31], a[176:179], a[124:127], a[28:31]
    s_add_u32 m0, s36, 67456
    v_mfma_f32_16x16x32_bf16 a[32:35], a[176:179], a[128:131], a[32:35]
    v_mfma_f32_16x16x32_bf16 a[36:39], a[176:179], a[132:135], a[36:39]
    buffer_load_dwordx4 v9, s[8:11], s29 offen offset:128  lds
    v_mfma_f32_16x16x32_bf16 a[40:43], a[176:179], a[136:139], a[40:43]
    s_mul_i32 s29, s49, s32
    v_mfma_f32_16x16x32_bf16 a[44:47], a[176:179], a[140:143], a[44:47]
    v_mfma_f32_16x16x32_bf16 a[48:51], a[160:163], a[112:115], a[48:51]
    s_add_u32 m0, s36, 68608
    v_mfma_f32_16x16x32_bf16 a[52:55], a[160:163], a[116:119], a[52:55]
    buffer_load_dwordx4 v10, s[12:15], s30 offen offset:0  lds
    v_mfma_f32_16x16x32_bf16 a[56:59], a[160:163], a[120:123], a[56:59]
    v_mfma_f32_16x16x32_bf16 a[60:63], a[160:163], a[124:127], a[60:63]
    s_mul_i32 s30, s49, s33
    v_mfma_f32_16x16x32_bf16 a[64:67], a[160:163], a[128:131], a[64:67]
    s_add_u32 m0, s36, 69632
    v_mfma_f32_16x16x32_bf16 a[68:71], a[160:163], a[132:135], a[68:71]
    v_mfma_f32_16x16x32_bf16 a[72:75], a[160:163], a[136:139], a[72:75]
    buffer_load_dwordx4 v11, s[16:19], s31 offen offset:0  lds
    v_mfma_f32_16x16x32_bf16 a[76:79], a[160:163], a[140:143], a[76:79]
    s_mul_i32 s31, s49, s34
    v_mfma_f32_16x16x32_bf16 a[80:83], a[180:183], a[112:115], a[80:83]
    v_mfma_f32_16x16x32_bf16 a[84:87], a[180:183], a[116:119], a[84:87]
    buffer_load_dword v17, v16, s[24:27], s43 offen
    v_mfma_f32_16x16x32_bf16 a[88:91], a[180:183], a[120:123], a[88:91]
    s_add_u32 s3, s3, 1
    v_mfma_f32_16x16x32_bf16 a[92:95], a[180:183], a[124:127], a[92:95]
    v_mfma_f32_16x16x32_bf16 a[96:99], a[180:183], a[128:131], a[96:99]
    s_and_b32 s3, s3, 15
    v_mfma_f32_16x16x32_bf16 a[100:103], a[180:183], a[132:135], a[100:103]
    s_mul_i32 s43, s3, s44
    v_mfma_f32_16x16x32_bf16 a[104:107], a[180:183], a[136:139], a[104:107]
    v_mfma_f32_16x16x32_bf16 a[108:111], a[180:183], a[140:143], a[108:111]
    s_waitcnt vmcnt(11) lgkmcnt(0)
    s_barrier
    v_mfma_f32_16x16x32_bf16 v[48:51], a[216:219], a[184:187], v[48:51]
    ds_read_b64_tr_b16 a[144:145], v15 offset:0
    v_mfma_f32_16x16x32_bf16 v[52:55], a[216:219], a[188:191], v[52:55]
    s_add_u32 m0, s35, 0
    v_mfma_f32_16x16x32_bf16 v[56:59], a[216:219], a[192:195], v[56:59]
    ds_read_b64_tr_b16 a[146:147], v15 offset:256
    v_mfma_f32_16x16x32_bf16 v[60:63], a[216:219], a[196:199], v[60:63]
    v_mfma_f32_16x16x32_bf16 v[64:67], a[216:219], a[200:203], v[64:67]
    ds_read_b128 a[112:115], v12 offset:32768
    v_mfma_f32_16x16x32_bf16 v[68:71], a[216:219], a[204:207], v[68:71]
    buffer_load_dwordx4 v1, s[4:7], s28 offen  lds
    v_mfma_f32_16x16x32_bf16 v[72:75], a[216:219], a[208:211], v[72:75]
    ds_read_b128 a[116:119], v12 offset:34816
    v_mfma_f32_16x16x32_bf16 v[76:79], a[216:219], a[212:215], v[76:79]
    v_mfma_f32_16x16x32_bf16 v[80:83], a[236:239], a[184:187], v[80:83]
    ds_read_b128 a[120:123], v12 offset:36864
    v_mfma_f32_16x16x32_bf16 v[84:87], a[236:239], a[188:191], v[84:87]
    v_mfma_f32_16x16x32_bf16 v[88:91], a[236:239], a[192:195], v[88:91]
    ds_read_b128 a[124:127], v12 offset:38912
    v_mfma_f32_16x16x32_bf16 v[92:95], a[236:239], a[196:199], v[92:95]
    s_add_u32 m0, s35, 1024
    v_mfma_f32_16x16x32_bf16 v[96:99], a[236:239], a[200:203], v[96:99]
    ds_read_b128 a[128:131], v12 offset:40960
    v_mfma_f32_16x16x32_bf16 v[100:103], a[236:239], a[204:207], v[100:103]
    v_mfma_f32_16x16x32_bf16 v[104:107], a[236:239], a[208:211], v[104:107]
    ds_read_b128 a[132:135], v12 offset:43008
    v_mfma_f32_16x16x32_bf16 v[108:111], a[236:239], a[212:215], v[108:111]
    v_mfma_f32_16x16x32_bf16 v[112:115], a[220:223], a[184:187], v[112:115]
    ds_read_b128 a[136:139], v12 offset:45056
    v_mfma_f32_16x16x32_bf16 v[116:119], a[220:223], a[188:191], v[116:119]
    buffer_load_dwordx4 v2, s[4:7], s28 offen  lds
    v_mfma_f32_16x16x32_bf16 v[120:123], a[220:223], a[192:195], v[120:123]
    ds_read_b128 a[140:143], v12 offset:47104
    v_mfma_f32_16x16x32_bf16 v[124:127], a[220:223], a[196:199], v[124:127]
    v_mfma_f32_16x16x32_bf16 v[128:131], a[220:223], a[200:203], v[128:131]
    ds_read_b64_tr_b16 a[164:165], v15 offset:5120
    v_mfma_f32_16x16x32_bf16 v[132:135], a[220:223], a[204:207], v[132:135]
    v_mfma_f32_16x16x32_bf16 v[136:139], a[220:223], a[208:211], v[136:139]
    ds_read_b64_tr_b16 a[166:167], v15 offset:5376
    v_mfma_f32_16x16x32_bf16 v[140:143], a[220:223], a[212:215], v[140:143]
    s_add_u32 m0, s35, 2048
    v_mfma_f32_16x16x32_bf16 v[144:147], a[240:243], a[184:187], v[144:147]
    ds_read_b64_tr_b16 a[148:149], v15 offset:1024
    v_mfma_f32_16x16x32_bf16 v[148:151], a[240:243], a[188:191], v[148:151]
    v_mfma_f32_16x16x32_bf16 v[152:155], a[240:243], a[192:195], v[152:155]
    ds_read_b64_tr_b16 a[150:151], v15 offset:1280
    v_mfma_f32_16x16x32_bf16 v[156:159], a[240:243], a[196:199], v[156:159]
    v_mfma_f32_16x16x32_bf16 v[160:163], a[240:243], a[200:203], v[160:163]
    ds_read_b64_tr_b16 a[168:169], v15 offset:6144
    v_mfma_f32_16x16x32_bf16 v[164:167], a[240:243], a[204:207], v[164:167]
    buffer_load_dwordx4 v3, s[4:7], s28 offen  lds
    v_mfma_f32_16x16x32_bf16 v[168:171], a[240:243], a[208:211], v[168:171]
    ds_read_b64_tr_b16 a[170:171], v15 offset:6400
    v_mfma_f32_16x16x32_bf16 v[172:175], a[240:243], a[212:215], v[172:175]
    v_mfma_f32_16x16x32_bf16 v[176:179], a[224:227], a[184:187], v[176:179]
    ds_read_b64_tr_b16 a[152:153], v15 offset:2048
    v_mfma_f32_16x16x32_bf16 v[180:183], a[224:227], a[188:191], v[180:183]
    v_mfma_f32_16x16x32_bf16 v[184:187], a[224:227], a[192:195], v[184:187]
    ds_read_b64_tr_b16 a[154:155], v15 offset:2304
    v_mfma_f32_16x16x32_bf16 v[188:191], a[224:227], a[196:199], v[188:191]
    s_add_u32 m0, s35, 3072
    v_mfma_f32_16x16x32_bf16 v[192:195], a[224:227], a[200:203], v[192:195]
    ds_read_b64_tr_b16 a[172:173], v15 offset:7168
    v_mfma_f32_16x16x32_bf16 v[196:199], a[224:227], a[204:207], v[196:199]
    v_mfma_f32_16x16x32_bf16 v[200:203], a[224:227], a[208:211], v[200:203]
    ds_read_b64_tr_b16 a[174:175], v15 offset:7424
    v_mfma_f32_16x16x32_bf16 v[204:207], a[224:227], a[212:215], v[204:207]
    buffer_load_dwordx4 v4, s[4:7], s28 offen  lds
    v_mfma_f32_16x16x32_bf16 v[208:211], a[244:247], a[184:187], v[208:211]
    ds_read_b64_tr_b16 a[156:157], v15 offset:3072
    v_mfma_f32_16x16x32_bf16 v[212:215], a[244:247], a[188:191], v[212:215]
    v_mfma_f32_16x16x32_bf16 v[216:219], a[244:247], a[192:195], v[216:219]
    ds_read_b64_tr_b16 a[158:159], v15 offset:3328
    v_mfma_f32_16x16x32_bf16 v[220:223], a[244:247], a[196:199], v[220:223]
    v_mfma_f32_16x16x32_bf16 v[224:227], a[244:247], a[200:203], v[224:227]
    ds_read_b64_tr_b16 a[176:177], v15 offset:8192
    v_mfma_f32_16x16x32_bf16 v[228:231], a[244:247], a[204:207], v[228:231]
    s_add_u32 m0, s35, 4096
    v_mfma_f32_16x16x32_bf16 v[232:235], a[244:247], a[208:211], v[232:235]
    ds_read_b64_tr_b16 a[178:179], v15 offset:8448
    v_mfma_f32_16x16x32_bf16 v[236:239], a[244:247], a[212:215], v[236:239]
    v_mfma_f32_16x16x32_bf16 v[240:243], a[228:231], a[184:187], v[240:243]
    ds_read_b64_tr_b16 a[160:161], v15 offset:4096
    v_mfma_f32_16x16x32_bf16 v[244:247], a[228:231], a[188:191], v[244:247]
    v_mfma_f32_16x16x32_bf16 v[248:251], a[228:231], a[192:195], v[248:251]
    ds_read_b64_tr_b16 a[162:163], v15 offset:4352
    v_mfma_f32_16x16x32_bf16 v[252:255], a[228:231], a[196:199], v[252:255]
    buffer_load_dwordx4 v5, s[4:7], s28 offen  lds
    v_mfma_f32_16x16x32_bf16 a[0:3], a[228:231], a[200:203], a[0:3]
    ds_read_b64_tr_b16 a[180:181], v15 offset:9216
    v_mfma_f32_16x16x32_bf16 a[4:7], a[228:231], a[204:207], a[4:7]
    v_mfma_f32_16x16x32_bf16 a[8:11], a[228:231], a[208:211], a[8:11]
    ds_read_b64_tr_b16 a[182:183], v15 offset:9472
    v_mfma_f32_16x16x32_bf16 a[12:15], a[228:231], a[212:215], a[12:15]
    v_mfma_f32_16x16x32_bf16 a[16:19], a[248:251], a[184:187], a[16:19]
    s_add_u32 m0, s35, 5120
    v_mfma_f32_16x16x32_bf16 a[20:23], a[248:251], a[188:191], a[20:23]
    v_mfma_f32_16x16x32_bf16 a[24:27], a[248:251], a[192:195], a[24:27]
    v_mfma_f32_16x16x32_bf16 a[28:31], a[248:251], a[196:199], a[28:31]
    buffer_load_dwordx4 v6, s[4:7], s28 offen  lds
    v_mfma_f32_16x16x32_bf16 a[32:35], a[248:251], a[200:203], a[32:35]
    v_mfma_f32_16x16x32_bf16 a[36:39], a[248:251], a[204:207], a[36:39]
    v_mfma_f32_16x16x32_bf16 a[40:43], a[248:251], a[208:211], a[40:43]
    s_add_u32 m0, s35, 6144
    v_mfma_f32_16x16x32_bf16 a[44:47], a[248:251], a[212:215], a[44:47]
    v_mfma_f32_16x16x32_bf16 a[48:51], a[232:235], a[184:187], a[48:51]
    buffer_load_dwordx4 v7, s[4:7], s28 offen  lds
    v_mfma_f32_16x16x32_bf16 a[52:55], a[232:235], a[188:191], a[52:55]
    v_mfma_f32_16x16x32_bf16 a[56:59], a[232:235], a[192:195], a[56:59]
    v_mfma_f32_16x16x32_bf16 a[60:63], a[232:235], a[196:199], a[60:63]
    s_add_u32 m0, s35, 7168
    v_mfma_f32_16x16x32_bf16 a[64:67], a[232:235], a[200:203], a[64:67]
    v_mfma_f32_16x16x32_bf16 a[68:71], a[232:235], a[204:207], a[68:71]
    v_mfma_f32_16x16x32_bf16 a[72:75], a[232:235], a[208:211], a[72:75]
    buffer_load_dwordx4 v8, s[4:7], s28 offen  lds
    v_mfma_f32_16x16x32_bf16 a[76:79], a[232:235], a[212:215], a[76:79]
    v_mfma_f32_16x16x32_bf16 a[80:83], a[252:255], a[184:187], a[80:83]
    v_mfma_f32_16x16x32_bf16 a[84:87], a[252:255], a[188:191], a[84:87]
    s_add_u32 s28, s28, 128
    v_mfma_f32_16x16x32_bf16 a[88:91], a[252:255], a[192:195], a[88:91]
    v_mfma_f32_16x16x32_bf16 a[92:95], a[252:255], a[196:199], a[92:95]
    v_mfma_f32_16x16x32_bf16 a[96:99], a[252:255], a[200:203], a[96:99]
    s_and_b32 s28, s28, 2047
    v_mfma_f32_16x16x32_bf16 a[100:103], a[252:255], a[204:207], a[100:103]
    v_mfma_f32_16x16x32_bf16 a[104:107], a[252:255], a[208:211], a[104:107]
    v_mfma_f32_16x16x32_bf16 a[108:111], a[252:255], a[212:215], a[108:111]
    s_waitcnt vmcnt(14) lgkmcnt(0)
    s_barrier
    v_mfma_f32_16x16x32_bf16 v[48:51], a[144:147], a[112:115], v[48:51]
    ds_read_b64_tr_b16 a[216:217], v15 offset:20480
    v_mfma_f32_16x16x32_bf16 v[52:55], a[144:147], a[116:119], v[52:55]
    s_add_u32 m0, s36, 86016
    v_mfma_f32_16x16x32_bf16 v[56:59], a[144:147], a[120:123], v[56:59]
    ds_read_b64_tr_b16 a[218:219], v15 offset:20736
    v_mfma_f32_16x16x32_bf16 v[60:63], a[144:147], a[124:127], v[60:63]
    buffer_load_dwordx4 v9, s[8:11], s29 offen offset:0  lds
    v_mfma_f32_16x16x32_bf16 v[64:67], a[144:147], a[128:131], v[64:67]
    ds_read_b128 a[184:187], v13 offset:32768
    v_mfma_f32_16x16x32_bf16 v[68:71], a[144:147], a[132:135], v[68:71]
    v_mfma_f32_16x16x32_bf16 v[72:75], a[144:147], a[136:139], v[72:75]
    ds_read_b128 a[188:191], v13 offset:34816
    v_mfma_f32_16x16x32_bf16 v[76:79], a[144:147], a[140:143], v[76:79]
    s_add_u32 s49, s49, 1
    v_mfma_f32_16x16x32_bf16 v[80:83], a[164:167], a[112:115], v[80:83]
    ds_read_b128 a[192:195], v13 offset:36864
    v_mfma_f32_16x16x32_bf16 v[84:87], a[164:167], a[116:119], v[84:87]
    s_add_u32 m0, s36, 86976
    v_mfma_f32_16x16x32_bf16 v[88:91], a[164:167], a[120:123], v[88:91]
    ds_read_b128 a[196:199], v13 offset:38912
    v_mfma_f32_16x16x32_bf16 v[92:95], a[164:167], a[124:127], v[92:95]
    v_mfma_f32_16x16x32_bf16 v[96:99], a[164:167], a[128:131], v[96:99]
    ds_read_b128 a[200:203], v13 offset:40960
    v_mfma_f32_16x16x32_bf16 v[100:103], a[164:167], a[132:135], v[100:103]
    buffer_load_dwordx4 v9, s[8:11], s29 offen offset:64  lds
    v_mfma_f32_16x16x32_bf16 v[104:107], a[164:167], a[136:139], v[104:107]
    ds_read_b128 a[204:207], v13 offset:43008
    v_mfma_f32_16x16x32_bf16 v[108:111], a[164:167], a[140:143], v[108:111]
    s_and_b32 s49, s49, 31
    v_mfma_f32_16x16x32_bf16 v[112:115], a[148:151], a[112:115], v[112:115]
    ds_read_b128 a[208:211], v13 offset:45056
    v_mfma_f32_16x16x32_bf16 v[116:119], a[148:151], a[116:119], v[116:119]
    v_mfma_f32_16x16x32_bf16 v[120:123], a[148:151], a[120:123], v[120:123]
    ds_read_b128 a[212:215], v13 offset:47104
    v_mfma_f32_16x16x32_bf16 v[124:127], a[148:151], a[124:127], v[124:127]
    s_add_u32 m0, s36, 87936
    v_mfma_f32_16x16x32_bf16 v[128:131], a[148:151], a[128:131], v[128:131]
    ds_read_b64_tr_b16 a[236:237], v15 offset:25600
    v_mfma_f32_16x16x32_bf16 v[132:135], a[148:151], a[132:135], v[132:135]
    buffer_load_dwordx4 v9, s[8:11], s29 offen offset:128  lds
    v_mfma_f32_16x16x32_bf16 v[136:139], a[148:151], a[136:139], v[136:139]
    ds_read_b64_tr_b16 a[238:239], v15 offset:25856
    v_mfma_f32_16x16x32_bf16 v[140:143], a[148:151], a[140:143], v[140:143]
    v_mfma_f32_16x16x32_bf16 v[144:147], a[168:171], a[112:115], v[144:147]
    ds_read_b64_tr_b16 a[220:221], v15 offset:21504
    v_mfma_f32_16x16x32_bf16 v[148:151], a[168:171], a[116:119], v[148:151]
    s_mul_i32 s29, s49, s32
    v_mfma_f32_16x16x32_bf16 v[152:155], a[168:171], a[120:123], v[152:155]
    ds_read_b64_tr_b16 a[222:223], v15 offset:21760
    v_mfma_f32_16x16x32_bf16 v[156:159], a[168:171], a[124:127], v[156:159]
    s_add_u32 m0, s36, 89088
    v_mfma_f32_16x16x32_bf16 v[160:163], a[168:171], a[128:131], v[160:163]
    ds_read_b64_tr_b16 a[240:241], v15 offset:26624
    v_mfma_f32_16x16x32_bf16 v[164:167], a[168:171], a[132:135], v[164:167]
    v_mfma_f32_16x16x32_bf16 v[168:171], a[168:171], a[136:139], v[168:171]
    ds_read_b64_tr_b16 a[242:243], v15 offset:26880
    v_mfma_f32_16x16x32_bf16 v[172:175], a[168:171], a[140:143], v[172:175]
    buffer_load_dwordx4 v10, s[12:15], s30 offen offset:0  lds
    v_mfma_f32_16x16x32_bf16 v[176:179], a[152:155], a[112:115], v[176:179]
    ds_read_b64_tr_b16 a[224:225], v15 offset:22528
    v_mfma_f32_16x16x32_bf16 v[180:183], a[152:155], a[116:119], v[180:183]
    s_mul_i32 s30, s49, s33
    v_mfma_f32_16x16x32_bf16 v[184:187], a[152:155], a[120:123], v[184:187]
    ds_read_b64_tr_b16 a[226:227], v15 offset:22784
    v_mfma_f32_16x16x32_bf16 v[188:191], a[152:155], a[124:127], v[188:191]
    v_mfma_f32_16x16x32_bf16 v[192:195], a[152:155], a[128:131], v[192:195]
    ds_read_b64_tr_b16 a[244:245], v15 offset:27648
    v_mfma_f32_16x16x32_bf16 v[196:199], a[152:155], a[132:135], v[196:199]
    s_add_u32 m0, s36, 90112
    v_mfma_f32_16x16x32_bf16 v[200:203], a[152:155], a[136:139], v[200:203]
    ds_read_b64_tr_b16 a[246:247], v15 offset:27904
    v_mfma_f32_16x16x32_bf16 v[204:207], a[152:155], a[140:143], v[204:207]
    buffer_load_dwordx4 v11, s[16:19], s31 offen offset:0  lds
    v_mfma_f32_16x16x32_bf16 v[208:211], a[172:175], a[112:115], v[208:211]
    ds_read_b64_tr_b16 a[228:229], v15 offset:23552
    v_mfma_f32_16x16x32_bf16 v[212:215], a[172:175], a[116:119], v[212:215]
    v_mfma_f32_16x16x32_bf16 v[216:219], a[172:175], a[120:123], v[216:219]
    ds_read_b64_tr_b16 a[230:231], v15 offset:23808
    v_mfma_f32_16x16x32_bf16 v[220:223], a[172:175], a[124:127], v[220:223]
    s_mul_i32 s31, s49, s34
    v_mfma_f32_16x16x32_bf16 v[224:227], a[172:175], a[128:131], v[224:227]
    ds_read_b64_tr_b16 a[248:249], v15 offset:28672
    v_mfma_f32_16x16x32_bf16 v[228:231], a[172:175], a[132:135], v[228:231]
    s_add_u32 m0, s36, 106496
    v_mfma_f32_16x16x32_bf16 v[232:235], a[172:175], a[136:139], v[232:235]
    ds_read_b64_tr_b16 a[250:251], v15 offset:28928
    v_mfma_f32_16x16x32_bf16 v[236:239], a[172:175], a[140:143], v[236:239]
    v_mfma_f32_16x16x32_bf16 v[240:243], a[156:159], a[112:115], v[240:243]
    ds_read_b64_tr_b16 a[232:233], v15 offset:24576
    v_mfma_f32_16x16x32_bf16 v[244:247], a[156:159], a[116:119], v[244:247]
    buffer_load_dwordx4 v9, s[8:11], s29 offen offset:0  lds
    v_mfma_f32_16x16x32_bf16 v[248:251], a[156:159], a[120:123], v[248:251]
    ds_read_b64_tr_b16 a[234:235], v15 offset:24832
    v_mfma_f32_16x16x32_bf16 v[252:255], a[156:159], a[124:127], v[252:255]
    s_add_u32 s49, s49, 1
    v_mfma_f32_16x16x32_bf16 a[0:3], a[156:159], a[128:131], a[0:3]
    ds_read_b64_tr_b16 a[252:253], v15 offset:29696
    v_mfma_f32_16x16x32_bf16 a[4:7], a[156:159], a[132:135], a[4:7]
    v_mfma_f32_16x16x32_bf16 a[8:11], a[156:159], a[136:139], a[8:11]
    ds_read_b64_tr_b16 a[254:255], v15 offset:29952
    v_mfma_f32_16x16x32_bf16 a[12:15], a[156:159], a[140:143], a[12:15]
    s_add_u32 m0, s36, 107456
    v_mfma_f32_16x16x32_bf16 a[16:19], a[176:179], a[112:115], a[16:19]
    buffer_load_dwordx4 v9, s[8:11], s29 offen offset:64  lds
    v_mfma_f32_16x16x32_bf16 a[20:23], a[176:179], a[116:119], a[20:23]
    v_mfma_f32_16x16x32_bf16 a[24:27], a[176:179], a[120:123], a[24:27]
    s_and_b32 s49, s49, 31
    v_mfma_f32_16x16x32_bf16 a[28:31], a[176:179], a[124:127], a[28:31]
    s_add_u32 m0, s36, 108416
    v_mfma_f32_16x16x32_bf16 a[32:35], a[176:179], a[128:131], a[32:35]
    v_mfma_f32_16x16x32_bf16 a[36:39], a[176:179], a[132:135], a[36:39]
    buffer_load_dwordx4 v9, s[8:11], s29 offen offset:128  lds
    v_mfma_f32_16x16x32_bf16 a[40:43], a[176:179], a[136:139], a[40:43]
    s_mul_i32 s29, s49, s32
    v_mfma_f32_16x16x32_bf16 a[44:47], a[176:179], a[140:143], a[44:47]
    v_mfma_f32_16x16x32_bf16 a[48:51], a[160:163], a[112:115], a[48:51]
    s_add_u32 m0, s36, 109568
    v_mfma_f32_16x16x32_bf16 a[52:55], a[160:163], a[116:119], a[52:55]
    buffer_load_dwordx4 v10, s[12:15], s30 offen offset:0  lds
    v_mfma_f32_16x16x32_bf16 a[56:59], a[160:163], a[120:123], a[56:59]
    v_mfma_f32_16x16x32_bf16 a[60:63], a[160:163], a[124:127], a[60:63]
    s_mul_i32 s30, s49, s33
    v_mfma_f32_16x16x32_bf16 a[64:67], a[160:163], a[128:131], a[64:67]
    s_add_u32 m0, s36, 110592
    v_mfma_f32_16x16x32_bf16 a[68:71], a[160:163], a[132:135], a[68:71]
    v_mfma_f32_16x16x32_bf16 a[72:75], a[160:163], a[136:139], a[72:75]
    buffer_load_dwordx4 v11, s[16:19], s31 offen offset:0  lds
    v_mfma_f32_16x16x32_bf16 a[76:79], a[160:163], a[140:143], a[76:79]
    s_mul_i32 s31, s49, s34
    v_mfma_f32_16x16x32_bf16 a[80:83], a[180:183], a[112:115], a[80:83]
    v_mfma_f32_16x16x32_bf16 a[84:87], a[180:183], a[116:119], a[84:87]
    buffer_load_dword v17, v16, s[24:27], s43 offen
    v_mfma_f32_16x16x32_bf16 a[88:91], a[180:183], a[120:123], a[88:91]
    s_add_u32 s3, s3, 1
    v_mfma_f32_16x16x32_bf16 a[92:95], a[180:183], a[124:127], a[92:95]
    v_mfma_f32_16x16x32_bf16 a[96:99], a[180:183], a[128:131], a[96:99]
    s_and_b32 s3, s3, 15
    v_mfma_f32_16x16x32_bf16 a[100:103], a[180:183], a[132:135], a[100:103]
    s_mul_i32 s43, s3, s44
    v_mfma_f32_16x16x32_bf16 a[104:107], a[180:183], a[136:139], a[104:107]
    v_mfma_f32_16x16x32_bf16 a[108:111], a[180:183], a[140:143], a[108:111]
    s_waitcnt vmcnt(11) lgkmcnt(0)
    s_barrier
    v_mfma_f32_16x16x32_bf16 v[48:51], a[216:219], a[184:187], v[48:51]
    ds_read_b64_tr_b16 a[144:145], v14 offset:0
    v_mfma_f32_16x16x32_bf16 v[52:55], a[216:219], a[188:191], v[52:55]
    s_add_u32 m0, s35, 32768
    v_mfma_f32_16x16x32_bf16 v[56:59], a[216:219], a[192:195], v[56:59]
    ds_read_b64_tr_b16 a[146:147], v14 offset:256
    v_mfma_f32_16x16x32_bf16 v[60:63], a[216:219], a[196:199], v[60:63]
    v_mfma_f32_16x16x32_bf16 v[64:67], a[216:219], a[200:203], v[64:67]
    ds_read_b128 a[112:115], v12 offset:0
    v_mfma_f32_16x16x32_bf16 v[68:71], a[216:219], a[204:207], v[68:71]
    buffer_load_dwordx4 v1, s[4:7], s28 offen  lds
    v_mfma_f32_16x16x32_bf16 v[72:75], a[216:219], a[208:211], v[72:75]
    ds_read_b128 a[116:119], v12 offset:2048
    v_mfma_f32_16x16x32_bf16 v[76:79], a[216:219], a[212:215], v[76:79]
    v_mfma_f32_16x16x32_bf16 v[80:83], a[236:239], a[184:187], v[80:83]
    ds_read_b128 a[120:123], v12 offset:4096
    v_mfma_f32_16x16x32_bf16 v[84:87], a[236:239], a[188:191], v[84:87]
    v_mfma_f32_16x16x32_bf16 v[88:91], a[236:239], a[192:195], v[88:91]
    ds_read_b128 a[124:127], v12 offset:6144
    v_mfma_f32_16x16x32_bf16 v[92:95], a[236:239], a[196:199], v[92:95]
    s_add_u32 m0, s35, 33792
    v_mfma_f32_16x16x32_bf16 v[96:99], a[236:239], a[200:203], v[96:99]
    ds_read_b128 a[128:131], v12 offset:8192
    v_mfma_f32_16x16x32_bf16 v[100:103], a[236:239], a[204:207], v[100:103]
    v_mfma_f32_16x16x32_bf16 v[104:107], a[236:239], a[208:211], v[104:107]
    ds_read_b128 a[132:135], v12 offset:10240
    v_mfma_f32_16x16x32_bf16 v[108:111], a[236:239], a[212:215], v[108:111]
    v_mfma_f32_16x16x32_bf16 v[112:115], a[220:223], a[184:187], v[112:115]
    ds_read_b128 a[136:139], v12 offset:12288
    v_mfma_f32_16x16x32_bf16 v[116:119], a[220:223], a[188:191], v[116:119]
    buffer_load_dwordx4 v2, s[4:7], s28 offen  lds
    v_mfma_f32_16x16x32_bf16 v[120:123], a[220:223], a[192:195], v[120:123]
    ds_read_b128 a[140:143], v12 offset:14336
    v_mfma_f32_16x16x32_bf16 v[124:127], a[220:223], a[196:199], v[124:127]
    v_mfma_f32_16x16x32_bf16 v[128:131], a[220:223], a[200:203], v[128:131]
    ds_read_b64_tr_b16 a[164:165], v14 offset:5120
    v_mfma_f32_16x16x32_bf16 v[132:135], a[220:223], a[204:207], v[132:135]
    v_mfma_f32_16x16x32_bf16 v[136:139], a[220:223], a[208:211], v[136:139]
    ds_read_b64_tr_b16 a[166:167], v14 offset:5376
    v_mfma_f32_16x16x32_bf16 v[140:143], a[220:223], a[212:215], v[140:143]
    s_add_u32 m0, s35, 34816
    v_mfma_f32_16x16x32_bf16 v[144:147], a[240:243], a[184:187], v[144:147]
    ds_read_b64_tr_b16 a[148:149], v14 offset:1024
    v_mfma_f32_16x16x32_bf16 v[148:151], a[240:243], a[188:191], v[148:151]
    v_mfma_f32_16x16x32_bf16 v[152:155], a[240:243], a[192:195], v[152:155]
    ds_read_b64_tr_b16 a[150:151], v14 offset:1280
    v_mfma_f32_16x16x32_bf16 v[156:159], a[240:243], a[196:199], v[156:159]
    v_mfma_f32_16x16x32_bf16 v[160:163], a[240:243], a[200:203], v[160:163]
    ds_read_b64_tr_b16 a[168:169], v14 offset:6144
    v_mfma_f32_16x16x32_bf16 v[164:167], a[240:243], a[204:207], v[164:167]
    buffer_load_dwordx4 v3, s[4:7], s28 offen  lds
    v_mfma_f32_16x16x32_bf16 v[168:171], a[240:243], a[208:211], v[168:171]
    ds_read_b64_tr_b16 a[170:171], v14 offset:6400
    v_mfma_f32_16x16x32_bf16 v[172:175], a[240:243], a[212:215], v[172:175]
    v_mfma_f32_16x16x32_bf16 v[176:179], a[224:227], a[184:187], v[176:179]
    ds_read_b64_tr_b16 a[152:153], v14 offset:2048
    v_mfma_f32_16x16x32_bf16 v[180:183], a[224:227], a[188:191], v[180:183]
    v_mfma_f32_16x16x32_bf16 v[184:187], a[224:227], a[192:195], v[184:187]
    ds_read_b64_tr_b16 a[154:155], v14 offset:2304
    v_mfma_f32_16x16x32_bf16 v[188:191], a[224:227], a[196:199], v[188:191]
    s_add_u32 m0, s35, 35840
    v_mfma_f32_16x16x32_bf16 v[192:195], a[224:227], a[200:203], v[192:195]
    ds_read_b64_tr_b16 a[172:173], v14 offset:7168
    v_mfma_f32_16x16x32_bf16 v[196:199], a[224:227], a[204:207], v[196:199]
    v_mfma_f32_16x16x32_bf16 v[200:203], a[224:227], a[208:211], v[200:203]
    ds_read_b64_tr_b16 a[174:175], v14 offset:7424
    v_mfma_f32_16x16x32_bf16 v[204:207], a[224:227], a[212:215], v[204:207]
    buffer_load_dwordx4 v4, s[4:7], s28 offen  lds
    v_mfma_f32_16x16x32_bf16 v[208:211], a[244:247], a[184:187], v[208:211]
    ds_read_b64_tr_b16 a[156:157], v14 offset:3072
    v_mfma_f32_16x16x32_bf16 v[212:215], a[244:247], a[188:191], v[212:215]
    v_mfma_f32_16x16x32_bf16 v[216:219], a[244:247], a[192:195], v[216:219]
    ds_read_b64_tr_b16 a[158:159], v14 offset:3328
    v_mfma_f32_16x16x32_bf16 v[220:223], a[244:247], a[196:199], v[220:223]
    v_mfma_f32_16x16x32_bf16 v[224:227], a[244:247], a[200:203], v[224:227]
    ds_read_b64_tr_b16 a[176:177], v14 offset:8192
    v_mfma_f32_16x16x32_bf16 v[228:231], a[244:247], a[204:207], v[228:231]
    s_add_u32 m0, s35, 36864
    v_mfma_f32_16x16x32_bf16 v[232:235], a[244:247], a[208:211], v[232:235]
    ds_read_b64_tr_b16 a[178:179], v14 offset:8448
    v_mfma_f32_16x16x32_bf16 v[236:239], a[244:247], a[212:215], v[236:239]
    v_mfma_f32_16x16x32_bf16 v[240:243], a[228:231], a[184:187], v[240:243]
    ds_read_b64_tr_b16 a[160:161], v14 offset:4096
    v_mfma_f32_16x16x32_bf16 v[244:247], a[228:231], a[188:191], v[244:247]
    v_mfma_f32_16x16x32_bf16 v[248:251], a[228:231], a[192:195], v[248:251]
    ds_read_b64_tr_b16 a[162:163], v14 offset:4352
    v_mfma_f32_16x16x32_bf16 v[252:255], a[228:231], a[196:199], v[252:255]
    buffer_load_dwordx4 v5, s[4:7], s28 offen  lds
    v_mfma_f32_16x16x32_bf16 a[0:3], a[228:231], a[200:203], a[0:3]
    ds_read_b64_tr_b16 a[180:181], v14 offset:9216
    v_mfma_f32_16x16x32_bf16 a[4:7], a[228:231], a[204:207], a[4:7]
    v_mfma_f32_16x16x32_bf16 a[8:11], a[228:231], a[208:211], a[8:11]
    ds_read_b64_tr_b16 a[182:183], v14 offset:9472
    v_mfma_f32_16x16x32_bf16 a[12:15], a[228:231], a[212:215], a[12:15]
    v_mfma_f32_16x16x32_bf16 a[16:19], a[248:251], a[184:187], a[16:19]
    s_add_u32 m0, s35, 37888
    v_mfma_f32_16x16x32_bf16 a[20:23], a[248:251], a[188:191], a[20:23]
    v_mfma_f32_16x16x32_bf16 a[24:27], a[248:251], a[192:195], a[24:27]
    v_mfma_f32_16x16x32_bf16 a[28:31], a[248:251], a[196:199], a[28:31]
    buffer_load_dwordx4 v6, s[4:7], s28 offen  lds
    v_mfma_f32_16x16x32_bf16 a[32:35], a[248:251], a[200:203], a[32:35]
    v_mfma_f32_16x16x32_bf16 a[36:39], a[248:251], a[204:207], a[36:39]
    v_mfma_f32_16x16x32_bf16 a[40:43], a[248:251], a[208:211], a[40:43]
    s_add_u32 m0, s35, 38912
    v_mfma_f32_16x16x32_bf16 a[44:47], a[248:251], a[212:215], a[44:47]
    v_mfma_f32_16x16x32_bf16 a[48:51], a[232:235], a[184:187], a[48:51]
    buffer_load_dwordx4 v7, s[4:7], s28 offen  lds
    v_mfma_f32_16x16x32_bf16 a[52:55], a[232:235], a[188:191], a[52:55]
    v_mfma_f32_16x16x32_bf16 a[56:59], a[232:235], a[192:195], a[56:59]
    v_mfma_f32_16x16x32_bf16 a[60:63], a[232:235], a[196:199], a[60:63]
    s_add_u32 m0, s35, 39936
    v_mfma_f32_16x16x32_bf16 a[64:67], a[232:235], a[200:203], a[64:67]
    v_mfma_f32_16x16x32_bf16 a[68:71], a[232:235], a[204:207], a[68:71]
    v_mfma_f32_16x16x32_bf16 a[72:75], a[232:235], a[208:211], a[72:75]
    buffer_load_dwordx4 v8, s[4:7], s28 offen  lds
    v_mfma_f32_16x16x32_bf16 a[76:79], a[232:235], a[212:215], a[76:79]
    v_mfma_f32_16x16x32_bf16 a[80:83], a[252:255], a[184:187], a[80:83]
    v_mfma_f32_16x16x32_bf16 a[84:87], a[252:255], a[188:191], a[84:87]
    s_add_u32 s28, s28, 128
    v_mfma_f32_16x16x32_bf16 a[88:91], a[252:255], a[192:195], a[88:91]
    v_mfma_f32_16x16x32_bf16 a[92:95], a[252:255], a[196:199], a[92:95]
    v_mfma_f32_16x16x32_bf16 a[96:99], a[252:255], a[200:203], a[96:99]
    s_and_b32 s28, s28, 2047
    v_mfma_f32_16x16x32_bf16 a[100:103], a[252:255], a[204:207], a[100:103]
    v_mfma_f32_16x16x32_bf16 a[104:107], a[252:255], a[208:211], a[104:107]
    v_mfma_f32_16x16x32_bf16 a[108:111], a[252:255], a[212:215], a[108:111]
    s_sub_u32 s37, s37, 1
    s_cmp_lg_u32 s37, 0
    s_cbranch_scc1 k1_kernel_loop
    s_waitcnt vmcnt(14) lgkmcnt(0)
    s_barrier
    v_mfma_f32_16x16x32_bf16 v[48:51], a[144:147], a[112:115], v[48:51]
    ds_read_b64_tr_b16 a[216:217], v14 offset:20480
    v_mfma_f32_16x16x32_bf16 v[52:55], a[144:147], a[116:119], v[52:55]
    s_add_u32 m0, s36, 126976
    v_mfma_f32_16x16x32_bf16 v[56:59], a[144:147], a[120:123], v[56:59]
    ds_read_b64_tr_b16 a[218:219], v14 offset:20736
    v_mfma_f32_16x16x32_bf16 v[60:63], a[144:147], a[124:127], v[60:63]
    buffer_load_dwordx4 v9, s[8:11], s29 offen offset:0  lds
    v_mfma_f32_16x16x32_bf16 v[64:67], a[144:147], a[128:131], v[64:67]
    ds_read_b128 a[184:187], v13 offset:0
    v_mfma_f32_16x16x32_bf16 v[68:71], a[144:147], a[132:135], v[68:71]
    s_add_u32 s49, s49, 1
    v_mfma_f32_16x16x32_bf16 v[72:75], a[144:147], a[136:139], v[72:75]
    ds_read_b128 a[188:191], v13 offset:2048
    v_mfma_f32_16x16x32_bf16 v[76:79], a[144:147], a[140:143], v[76:79]
    v_mfma_f32_16x16x32_bf16 v[80:83], a[164:167], a[112:115], v[80:83]
    ds_read_b128 a[192:195], v13 offset:4096
    v_mfma_f32_16x16x32_bf16 v[84:87], a[164:167], a[116:119], v[84:87]
    s_add_u32 m0, s36, 127936
    v_mfma_f32_16x16x32_bf16 v[88:91], a[164:167], a[120:123], v[88:91]
    ds_read_b128 a[196:199], v13 offset:6144
    v_mfma_f32_16x16x32_bf16 v[92:95], a[164:167], a[124:127], v[92:95]
    buffer_load_dwordx4 v9, s[8:11], s29 offen offset:64  lds
    v_mfma_f32_16x16x32_bf16 v[96:99], a[164:167], a[128:131], v[96:99]
    ds_read_b128 a[200:203], v13 offset:8192
    v_mfma_f32_16x16x32_bf16 v[100:103], a[164:167], a[132:135], v[100:103]
    s_and_b32 s49, s49, 31
    v_mfma_f32_16x16x32_bf16 v[104:107], a[164:167], a[136:139], v[104:107]
    ds_read_b128 a[204:207], v13 offset:10240
    v_mfma_f32_16x16x32_bf16 v[108:111], a[164:167], a[140:143], v[108:111]
    v_mfma_f32_16x16x32_bf16 v[112:115], a[148:151], a[112:115], v[112:115]
    ds_read_b128 a[208:211], v13 offset:12288
    v_mfma_f32_16x16x32_bf16 v[116:119], a[148:151], a[116:119], v[116:119]
    s_add_u32 m0, s36, 128896
    v_mfma_f32_16x16x32_bf16 v[120:123], a[148:151], a[120:123], v[120:123]
    ds_read_b128 a[212:215], v13 offset:14336
    v_mfma_f32_16x16x32_bf16 v[124:127], a[148:151], a[124:127], v[124:127]
    buffer_load_dwordx4 v9, s[8:11], s29 offen offset:128  lds
    v_mfma_f32_16x16x32_bf16 v[128:131], a[148:151], a[128:131], v[128:131]
    ds_read_b64_tr_b16 a[236:237], v14 offset:25600
    v_mfma_f32_16x16x32_bf16 v[132:135], a[148:151], a[132:135], v[132:135]
    v_mfma_f32_16x16x32_bf16 v[136:139], a[148:151], a[136:139], v[136:139]
    ds_read_b64_tr_b16 a[238:239], v14 offset:25856
    v_mfma_f32_16x16x32_bf16 v[140:143], a[148:151], a[140:143], v[140:143]
    s_mul_i32 s29, s49, s32
    v_mfma_f32_16x16x32_bf16 v[144:147], a[168:171], a[112:115], v[144:147]
    ds_read_b64_tr_b16 a[220:221], v14 offset:21504
    v_mfma_f32_16x16x32_bf16 v[148:151], a[168:171], a[116:119], v[148:151]
    s_add_u32 m0, s36, 130048
    v_mfma_f32_16x16x32_bf16 v[152:155], a[168:171], a[120:123], v[152:155]
    ds_read_b64_tr_b16 a[222:223], v14 offset:21760
    v_mfma_f32_16x16x32_bf16 v[156:159], a[168:171], a[124:127], v[156:159]
    buffer_load_dwordx4 v10, s[12:15], s30 offen offset:0  lds
    v_mfma_f32_16x16x32_bf16 v[160:163], a[168:171], a[128:131], v[160:163]
    ds_read_b64_tr_b16 a[240:241], v14 offset:26624
    v_mfma_f32_16x16x32_bf16 v[164:167], a[168:171], a[132:135], v[164:167]
    v_mfma_f32_16x16x32_bf16 v[168:171], a[168:171], a[136:139], v[168:171]
    ds_read_b64_tr_b16 a[242:243], v14 offset:26880
    v_mfma_f32_16x16x32_bf16 v[172:175], a[168:171], a[140:143], v[172:175]
    s_mul_i32 s30, s49, s33
    v_mfma_f32_16x16x32_bf16 v[176:179], a[152:155], a[112:115], v[176:179]
    ds_read_b64_tr_b16 a[224:225], v14 offset:22528
    v_mfma_f32_16x16x32_bf16 v[180:183], a[152:155], a[116:119], v[180:183]
    s_add_u32 m0, s36, 131072
    v_mfma_f32_16x16x32_bf16 v[184:187], a[152:155], a[120:123], v[184:187]
    ds_read_b64_tr_b16 a[226:227], v14 offset:22784
    v_mfma_f32_16x16x32_bf16 v[188:191], a[152:155], a[124:127], v[188:191]
    buffer_load_dwordx4 v11, s[16:19], s31 offen offset:0  lds
    v_mfma_f32_16x16x32_bf16 v[192:195], a[152:155], a[128:131], v[192:195]
    ds_read_b64_tr_b16 a[244:245], v14 offset:27648
    v_mfma_f32_16x16x32_bf16 v[196:199], a[152:155], a[132:135], v[196:199]
    v_mfma_f32_16x16x32_bf16 v[200:203], a[152:155], a[136:139], v[200:203]
    ds_read_b64_tr_b16 a[246:247], v14 offset:27904
    v_mfma_f32_16x16x32_bf16 v[204:207], a[152:155], a[140:143], v[204:207]
    s_mul_i32 s31, s49, s34
    v_mfma_f32_16x16x32_bf16 v[208:211], a[172:175], a[112:115], v[208:211]
    ds_read_b64_tr_b16 a[228:229], v14 offset:23552
    v_mfma_f32_16x16x32_bf16 v[212:215], a[172:175], a[116:119], v[212:215]
    buffer_store_dwordx4 v[20:23], v18, s[20:23], s57 offen offset:0 sc1
    v_mfma_f32_16x16x32_bf16 v[216:219], a[172:175], a[120:123], v[216:219]
    ds_read_b64_tr_b16 a[230:231], v14 offset:23808
    v_mfma_f32_16x16x32_bf16 v[220:223], a[172:175], a[124:127], v[220:223]
    v_mfma_f32_16x16x32_bf16 v[224:227], a[172:175], a[128:131], v[224:227]
    ds_read_b64_tr_b16 a[248:249], v14 offset:28672
    v_mfma_f32_16x16x32_bf16 v[228:231], a[172:175], a[132:135], v[228:231]
    buffer_store_dwordx4 v[20:23], v18, s[20:23], s57 offen offset:1024 sc1
    v_mfma_f32_16x16x32_bf16 v[232:235], a[172:175], a[136:139], v[232:235]
    ds_read_b64_tr_b16 a[250:251], v14 offset:28928
    v_mfma_f32_16x16x32_bf16 v[236:239], a[172:175], a[140:143], v[236:239]
    buffer_store_dwordx4 v[20:23], v18, s[20:23], s57 offen offset:2048 sc1
    v_mfma_f32_16x16x32_bf16 v[240:243], a[156:159], a[112:115], v[240:243]
    ds_read_b64_tr_b16 a[232:233], v14 offset:24576
    v_mfma_f32_16x16x32_bf16 v[244:247], a[156:159], a[116:119], v[244:247]
    buffer_store_dwordx4 v[20:23], v18, s[20:23], s57 offen offset:3072 sc1
    v_mfma_f32_16x16x32_bf16 v[248:251], a[156:159], a[120:123], v[248:251]
    ds_read_b64_tr_b16 a[234:235], v14 offset:24832
    v_mfma_f32_16x16x32_bf16 v[252:255], a[156:159], a[124:127], v[252:255]
    v_mfma_f32_16x16x32_bf16 a[0:3], a[156:159], a[128:131], a[0:3]
    ds_read_b64_tr_b16 a[252:253], v14 offset:29696
    v_mfma_f32_16x16x32_bf16 a[4:7], a[156:159], a[132:135], a[4:7]
    s_lshl_b32 s59, s58, 2
    v_mfma_f32_16x16x32_bf16 a[8:11], a[156:159], a[136:139], a[8:11]
    ds_read_b64_tr_b16 a[254:255], v14 offset:29952
    v_mfma_f32_16x16x32_bf16 a[12:15], a[156:159], a[140:143], a[12:15]
    s_add_u32 s59, s59, 0x2200000
    v_mfma_f32_16x16x32_bf16 a[16:19], a[176:179], a[112:115], a[16:19]
    v_mov_b32 v18, 0
    v_mfma_f32_16x16x32_bf16 a[20:23], a[176:179], a[116:119], a[20:23]
    v_mfma_f32_16x16x32_bf16 a[24:27], a[176:179], a[120:123], a[24:27]
    s_mov_b32 exec_lo, 0
    s_mov_b32 exec_hi, 0x80000000
    buffer_store_dwordx2 v[46:47], v18, s[20:23], s59 offen
    s_lshl_b32 s59, s58, 4
    s_add_u32 s59, s59, 0x2300000
    s_mov_b64 exec, 0xff
    v_lshlrev_b32 v19, 2, v0
    buffer_store_dword v18, v19, s[20:23], s59 offen
    s_mov_b64 exec, -1
    v_mfma_f32_16x16x32_bf16 a[28:31], a[176:179], a[124:127], a[28:31]
    s_mov_b32 s80, s74
    v_mfma_f32_16x16x32_bf16 a[32:35], a[176:179], a[128:131], a[32:35]
    v_mfma_f32_16x16x32_bf16 a[36:39], a[176:179], a[132:135], a[36:39]
    s_mov_b32 s81, s75
    v_mfma_f32_16x16x32_bf16 a[40:43], a[176:179], a[136:139], a[40:43]
    s_mov_b32 s82, 2097152
    v_mfma_f32_16x16x32_bf16 a[44:47], a[176:179], a[140:143], a[44:47]
    s_lshl_b32 s59, s58, 10
    v_mfma_f32_16x16x32_bf16 a[48:51], a[160:163], a[112:115], a[48:51]
    v_mfma_f32_16x16x32_bf16 a[52:55], a[160:163], a[116:119], a[52:55]
    v_lshlrev_b32 v18, 5, v0
    v_mfma_f32_16x16x32_bf16 a[56:59], a[160:163], a[120:123], a[56:59]
    buffer_load_dword v6, v18, s[80:83], s59 offen
    v_mfma_f32_16x16x32_bf16 a[60:63], a[160:163], a[124:127], a[60:63]
    s_getpc_b64 s[24:25]
k1_kernel_pc:
    v_mfma_f32_16x16x32_bf16 a[64:67], a[160:163], a[128:131], a[64:67]
    v_mfma_f32_16x16x32_bf16 a[68:71], a[160:163], a[132:135], a[68:71]
    s_mov_b32 s26, k2_kernel_end-k1_kernel_pc
    v_mfma_f32_16x16x32_bf16 a[72:75], a[160:163], a[136:139], a[72:75]
    s_lshr_b32 s50, s2, 3
    v_mfma_f32_16x16x32_bf16 a[76:79], a[160:163], a[140:143], a[76:79]
    v_mfma_f32_16x16x32_bf16 a[80:83], a[180:183], a[112:115], a[80:83]
    s_lshl_b32 s50, s50, 2
    v_mfma_f32_16x16x32_bf16 a[84:87], a[180:183], a[116:119], a[84:87]
    s_add_u32 s50, s50, s38
    v_mfma_f32_16x16x32_bf16 a[88:91], a[180:183], a[120:123], a[88:91]
    s_lshl_b32 s50, s50, 9
    v_mfma_f32_16x16x32_bf16 a[92:95], a[180:183], a[124:127], a[92:95]
    v_mfma_f32_16x16x32_bf16 a[96:99], a[180:183], a[128:131], a[96:99]
    v_lshlrev_b32 v16, 3, v0
    v_mfma_f32_16x16x32_bf16 a[100:103], a[180:183], a[132:135], a[100:103]
    buffer_load_dword v5, v16, s[24:27], s50 offen
    v_mfma_f32_16x16x32_bf16 a[104:107], a[180:183], a[136:139], a[104:107]
    v_mfma_f32_16x16x32_bf16 a[108:111], a[180:183], a[140:143], a[108:111]
    s_waitcnt vmcnt(13) lgkmcnt(0)
    s_barrier
    v_mfma_f32_16x16x32_bf16 v[48:51], a[216:219], a[184:187], v[48:51]
    ds_read_b64_tr_b16 a[144:145], v15 offset:0
    v_mfma_f32_16x16x32_bf16 v[52:55], a[216:219], a[188:191], v[52:55]
    v_mfma_f32_16x16x32_bf16 v[56:59], a[216:219], a[192:195], v[56:59]
    ds_read_b64_tr_b16 a[146:147], v15 offset:256
    v_mfma_f32_16x16x32_bf16 v[60:63], a[216:219], a[196:199], v[60:63]
    v_mfma_f32_16x16x32_bf16 v[64:67], a[216:219], a[200:203], v[64:67]
    ds_read_b128 a[112:115], v12 offset:32768
    v_mfma_f32_16x16x32_bf16 v[68:71], a[216:219], a[204:207], v[68:71]
    v_mfma_f32_16x16x32_bf16 v[72:75], a[216:219], a[208:211], v[72:75]
    ds_read_b128 a[116:119], v12 offset:34816
    v_mfma_f32_16x16x32_bf16 v[76:79], a[216:219], a[212:215], v[76:79]
    v_mfma_f32_16x16x32_bf16 v[80:83], a[236:239], a[184:187], v[80:83]
    ds_read_b128 a[120:123], v12 offset:36864
    v_mfma_f32_16x16x32_bf16 v[84:87], a[236:239], a[188:191], v[84:87]
    v_mfma_f32_16x16x32_bf16 v[88:91], a[236:239], a[192:195], v[88:91]
    ds_read_b128 a[124:127], v12 offset:38912
    v_mfma_f32_16x16x32_bf16 v[92:95], a[236:239], a[196:199], v[92:95]
    v_mfma_f32_16x16x32_bf16 v[96:99], a[236:239], a[200:203], v[96:99]
    ds_read_b128 a[128:131], v12 offset:40960
    v_mfma_f32_16x16x32_bf16 v[100:103], a[236:239], a[204:207], v[100:103]
    v_mfma_f32_16x16x32_bf16 v[104:107], a[236:239], a[208:211], v[104:107]
    ds_read_b128 a[132:135], v12 offset:43008
    v_mfma_f32_16x16x32_bf16 v[108:111], a[236:239], a[212:215], v[108:111]
    v_mfma_f32_16x16x32_bf16 v[112:115], a[220:223], a[184:187], v[112:115]
    ds_read_b128 a[136:139], v12 offset:45056
    v_mfma_f32_16x16x32_bf16 v[116:119], a[220:223], a[188:191], v[116:119]
    v_mfma_f32_16x16x32_bf16 v[120:123], a[220:223], a[192:195], v[120:123]
    ds_read_b128 a[140:143], v12 offset:47104
    v_mfma_f32_16x16x32_bf16 v[124:127], a[220:223], a[196:199], v[124:127]
    v_mfma_f32_16x16x32_bf16 v[128:131], a[220:223], a[200:203], v[128:131]
    ds_read_b64_tr_b16 a[164:165], v15 offset:5120
    v_mfma_f32_16x16x32_bf16 v[132:135], a[220:223], a[204:207], v[132:135]
    v_mfma_f32_16x16x32_bf16 v[136:139], a[220:223], a[208:211], v[136:139]
    ds_read_b64_tr_b16 a[166:167], v15 offset:5376
    v_mfma_f32_16x16x32_bf16 v[140:143], a[220:223], a[212:215], v[140:143]
    v_mfma_f32_16x16x32_bf16 v[144:147], a[240:243], a[184:187], v[144:147]
    ds_read_b64_tr_b16 a[148:149], v15 offset:1024
    v_mfma_f32_16x16x32_bf16 v[148:151], a[240:243], a[188:191], v[148:151]
    v_mfma_f32_16x16x32_bf16 v[152:155], a[240:243], a[192:195], v[152:155]
    ds_read_b64_tr_b16 a[150:151], v15 offset:1280
    v_mfma_f32_16x16x32_bf16 v[156:159], a[240:243], a[196:199], v[156:159]
    v_mfma_f32_16x16x32_bf16 v[160:163], a[240:243], a[200:203], v[160:163]
    ds_read_b64_tr_b16 a[168:169], v15 offset:6144
    v_mfma_f32_16x16x32_bf16 v[164:167], a[240:243], a[204:207], v[164:167]
    v_mfma_f32_16x16x32_bf16 v[168:171], a[240:243], a[208:211], v[168:171]
    ds_read_b64_tr_b16 a[170:171], v15 offset:6400
    v_mfma_f32_16x16x32_bf16 v[172:175], a[240:243], a[212:215], v[172:175]
    v_mfma_f32_16x16x32_bf16 v[176:179], a[224:227], a[184:187], v[176:179]
    ds_read_b64_tr_b16 a[152:153], v15 offset:2048
    v_mfma_f32_16x16x32_bf16 v[180:183], a[224:227], a[188:191], v[180:183]
    v_mfma_f32_16x16x32_bf16 v[184:187], a[224:227], a[192:195], v[184:187]
    ds_read_b64_tr_b16 a[154:155], v15 offset:2304
    v_mfma_f32_16x16x32_bf16 v[188:191], a[224:227], a[196:199], v[188:191]
    v_mfma_f32_16x16x32_bf16 v[192:195], a[224:227], a[200:203], v[192:195]
    ds_read_b64_tr_b16 a[172:173], v15 offset:7168
    v_mfma_f32_16x16x32_bf16 v[196:199], a[224:227], a[204:207], v[196:199]
    v_mfma_f32_16x16x32_bf16 v[200:203], a[224:227], a[208:211], v[200:203]
    ds_read_b64_tr_b16 a[174:175], v15 offset:7424
    v_mfma_f32_16x16x32_bf16 v[204:207], a[224:227], a[212:215], v[204:207]
    v_mfma_f32_16x16x32_bf16 v[208:211], a[244:247], a[184:187], v[208:211]
    ds_read_b64_tr_b16 a[156:157], v15 offset:3072
    v_mfma_f32_16x16x32_bf16 v[212:215], a[244:247], a[188:191], v[212:215]
    v_mfma_f32_16x16x32_bf16 v[216:219], a[244:247], a[192:195], v[216:219]
    ds_read_b64_tr_b16 a[158:159], v15 offset:3328
    v_mfma_f32_16x16x32_bf16 v[220:223], a[244:247], a[196:199], v[220:223]
    v_mfma_f32_16x16x32_bf16 v[224:227], a[244:247], a[200:203], v[224:227]
    ds_read_b64_tr_b16 a[176:177], v15 offset:8192
    v_mfma_f32_16x16x32_bf16 v[228:231], a[244:247], a[204:207], v[228:231]
    v_mfma_f32_16x16x32_bf16 v[232:235], a[244:247], a[208:211], v[232:235]
    ds_read_b64_tr_b16 a[178:179], v15 offset:8448
    v_mfma_f32_16x16x32_bf16 v[236:239], a[244:247], a[212:215], v[236:239]
    v_mfma_f32_16x16x32_bf16 v[240:243], a[228:231], a[184:187], v[240:243]
    ds_read_b64_tr_b16 a[160:161], v15 offset:4096
    v_mfma_f32_16x16x32_bf16 v[244:247], a[228:231], a[188:191], v[244:247]
    v_mfma_f32_16x16x32_bf16 v[248:251], a[228:231], a[192:195], v[248:251]
    ds_read_b64_tr_b16 a[162:163], v15 offset:4352
    v_mfma_f32_16x16x32_bf16 v[252:255], a[228:231], a[196:199], v[252:255]
    v_mfma_f32_16x16x32_bf16 a[0:3], a[228:231], a[200:203], a[0:3]
    ds_read_b64_tr_b16 a[180:181], v15 offset:9216
    v_mfma_f32_16x16x32_bf16 a[4:7], a[228:231], a[204:207], a[4:7]
    v_mfma_f32_16x16x32_bf16 a[8:11], a[228:231], a[208:211], a[8:11]
    ds_read_b64_tr_b16 a[182:183], v15 offset:9472
    v_mfma_f32_16x16x32_bf16 a[12:15], a[228:231], a[212:215], a[12:15]
    v_mfma_f32_16x16x32_bf16 a[16:19], a[248:251], a[184:187], a[16:19]
    v_mfma_f32_16x16x32_bf16 a[20:23], a[248:251], a[188:191], a[20:23]
    v_mfma_f32_16x16x32_bf16 a[24:27], a[248:251], a[192:195], a[24:27]
    v_mfma_f32_16x16x32_bf16 a[28:31], a[248:251], a[196:199], a[28:31]
    v_mfma_f32_16x16x32_bf16 a[32:35], a[248:251], a[200:203], a[32:35]
    v_mfma_f32_16x16x32_bf16 a[36:39], a[248:251], a[204:207], a[36:39]
    v_mfma_f32_16x16x32_bf16 a[40:43], a[248:251], a[208:211], a[40:43]
    v_mfma_f32_16x16x32_bf16 a[44:47], a[248:251], a[212:215], a[44:47]
    v_mfma_f32_16x16x32_bf16 a[48:51], a[232:235], a[184:187], a[48:51]
    v_mfma_f32_16x16x32_bf16 a[52:55], a[232:235], a[188:191], a[52:55]
    v_mfma_f32_16x16x32_bf16 a[56:59], a[232:235], a[192:195], a[56:59]
    v_mfma_f32_16x16x32_bf16 a[60:63], a[232:235], a[196:199], a[60:63]
    v_mfma_f32_16x16x32_bf16 a[64:67], a[232:235], a[200:203], a[64:67]
    v_mfma_f32_16x16x32_bf16 a[68:71], a[232:235], a[204:207], a[68:71]
    v_mfma_f32_16x16x32_bf16 a[72:75], a[232:235], a[208:211], a[72:75]
    v_mfma_f32_16x16x32_bf16 a[76:79], a[232:235], a[212:215], a[76:79]
    v_mfma_f32_16x16x32_bf16 a[80:83], a[252:255], a[184:187], a[80:83]
    v_mfma_f32_16x16x32_bf16 a[84:87], a[252:255], a[188:191], a[84:87]
    v_mfma_f32_16x16x32_bf16 a[88:91], a[252:255], a[192:195], a[88:91]
    v_mfma_f32_16x16x32_bf16 a[92:95], a[252:255], a[196:199], a[92:95]
    v_mfma_f32_16x16x32_bf16 a[96:99], a[252:255], a[200:203], a[96:99]
    v_mfma_f32_16x16x32_bf16 a[100:103], a[252:255], a[204:207], a[100:103]
    v_mfma_f32_16x16x32_bf16 a[104:107], a[252:255], a[208:211], a[104:107]
    v_mfma_f32_16x16x32_bf16 a[108:111], a[252:255], a[212:215], a[108:111]
    v_lshlrev_b32 v1, 4, v0
    s_mov_b32 s70, 0xbfb8aa3b
    s_mov_b32 s71, 0xbfb8aa3b
    s_lshl_b32 s50, s41, 3
    s_lshl_b32 s51, s39, 2
    s_add_u32 s50, s50, s51
    s_mul_i32 s72, s50, 294912
    s_lshl_b32 s51, s45, 6
    s_add_u32 s72, s72, s51
    s_lshl_b32 s51, s40, 10
    s_add_u32 s72, s72, s51
    s_add_u32 s72, s72, 16842752
    s_lshl_b32 s73, s50, 10
    s_lshl_b32 s51, s40, 16
    s_add_u32 s73, s73, s51
    s_lshl_b32 s69, s50, 11
    s_lshl_b32 s51, s40, 8
    s_add_u32 s69, s69, s51
    v_and_b32 v18, 15, v0
    v_lshrrev_b32 v19, 4, v0
    v_lshlrev_b32 v2, 4, v18
    v_lshl_add_u32 v2, v19, 9, v2
    v_lshlrev_b32 v3, 5, v18
    v_lshl_add_u32 v3, v19, 3, v3
    v_add_u32 v3, s35, v3
    v_lshrrev_b32 v4, 5, v0
    v_lshlrev_b32 v4, 9, v4
    v_and_b32 v19, 1, v19
    v_lshl_add_u32 v4, v19, 7, v4
    v_lshrrev_b32 v19, 2, v18
    v_lshl_add_u32 v4, v19, 5, v4
    v_and_b32 v19, 3, v18
    v_lshl_add_u32 v4, v19, 3, v4
    v_add_u32 v4, s35, v4
    s_waitcnt vmcnt(8) lgkmcnt(0)
    s_barrier
    v_mfma_f32_16x16x32_bf16 v[48:51], a[144:147], a[112:115], v[48:51]
    ds_read_b64_tr_b16 a[216:217], v15 offset:20480
    ds_read_b64_tr_b16 a[218:219], v15 offset:20736
    v_mfma_f32_16x16x32_bf16 v[52:55], a[144:147], a[116:119], v[52:55]
    ds_read_b128 a[184:187], v13 offset:32768
    ds_read_b128 a[188:191], v13 offset:34816
    v_mfma_f32_16x16x32_bf16 v[56:59], a[144:147], a[120:123], v[56:59]
    ds_read_b128 a[192:195], v13 offset:36864
    ds_read_b128 a[196:199], v13 offset:38912
    v_mfma_f32_16x16x32_bf16 v[60:63], a[144:147], a[124:127], v[60:63]
    ds_read_b128 a[200:203], v13 offset:40960
    ds_read_b128 a[204:207], v13 offset:43008
    v_mfma_f32_16x16x32_bf16 v[64:67], a[144:147], a[128:131], v[64:67]
    ds_read_b128 a[208:211], v13 offset:45056
    ds_read_b128 a[212:215], v13 offset:47104
    v_mfma_f32_16x16x32_bf16 v[68:71], a[144:147], a[132:135], v[68:71]
    ds_read_b64_tr_b16 a[236:237], v15 offset:25600
    ds_read_b64_tr_b16 a[238:239], v15 offset:25856
    v_mfma_f32_16x16x32_bf16 v[72:75], a[144:147], a[136:139], v[72:75]
    ds_read_b64_tr_b16 a[220:221], v15 offset:21504
    ds_read_b64_tr_b16 a[222:223], v15 offset:21760
    v_mfma_f32_16x16x32_bf16 v[76:79], a[144:147], a[140:143], v[76:79]
    ds_read_b64_tr_b16 a[240:241], v15 offset:26624
    ds_read_b64_tr_b16 a[242:243], v15 offset:26880
    v_mfma_f32_16x16x32_bf16 v[80:83], a[164:167], a[112:115], v[80:83]
    ds_read_b64_tr_b16 a[224:225], v15 offset:22528
    ds_read_b64_tr_b16 a[226:227], v15 offset:22784
    v_mfma_f32_16x16x32_bf16 v[84:87], a[164:167], a[116:119], v[84:87]
    ds_read_b64_tr_b16 a[244:245], v15 offset:27648
    ds_read_b64_tr_b16 a[246:247], v15 offset:27904
    v_mfma_f32_16x16x32_bf16 v[88:91], a[164:167], a[120:123], v[88:91]
    ds_read_b64_tr_b16 a[228:229], v15 offset:23552
    ds_read_b64_tr_b16 a[230:231], v15 offset:23808
    v_mfma_f32_16x16x32_bf16 v[92:95], a[164:167], a[124:127], v[92:95]
    ds_read_b64_tr_b16 a[248:249], v15 offset:28672
    ds_read_b64_tr_b16 a[250:251], v15 offset:28928
    v_mfma_f32_16x16x32_bf16 v[96:99], a[164:167], a[128:131], v[96:99]
    ds_read_b64_tr_b16 a[232:233], v15 offset:24576
    ds_read_b64_tr_b16 a[234:235], v15 offset:24832
    v_mfma_f32_16x16x32_bf16 v[100:103], a[164:167], a[132:135], v[100:103]
    ds_read_b64_tr_b16 a[252:253], v15 offset:29696
    ds_read_b64_tr_b16 a[254:255], v15 offset:29952
    v_mfma_f32_16x16x32_bf16 v[104:107], a[164:167], a[136:139], v[104:107]
    v_mfma_f32_16x16x32_bf16 v[108:111], a[164:167], a[140:143], v[108:111]
    s_waitcnt lgkmcnt(0)
    v_mfma_f32_16x16x32_bf16 v[48:51], a[216:219], a[184:187], v[48:51]
    v_mfma_f32_16x16x32_bf16 v[52:55], a[216:219], a[188:191], v[52:55]
    v_mfma_f32_16x16x32_bf16 v[56:59], a[216:219], a[192:195], v[56:59]
    v_mfma_f32_16x16x32_bf16 v[60:63], a[216:219], a[196:199], v[60:63]
    v_mfma_f32_16x16x32_bf16 v[64:67], a[216:219], a[200:203], v[64:67]
    v_mfma_f32_16x16x32_bf16 v[68:71], a[216:219], a[204:207], v[68:71]
    v_mfma_f32_16x16x32_bf16 v[72:75], a[216:219], a[208:211], v[72:75]
    v_mfma_f32_16x16x32_bf16 v[76:79], a[216:219], a[212:215], v[76:79]
    v_mfma_f32_16x16x32_bf16 v[80:83], a[236:239], a[184:187], v[80:83]
    v_mfma_f32_16x16x32_bf16 v[84:87], a[236:239], a[188:191], v[84:87]
    v_mfma_f32_16x16x32_bf16 v[88:91], a[236:239], a[192:195], v[88:91]
    v_mfma_f32_16x16x32_bf16 v[92:95], a[236:239], a[196:199], v[92:95]
    v_mfma_f32_16x16x32_bf16 v[96:99], a[236:239], a[200:203], v[96:99]
    v_mfma_f32_16x16x32_bf16 v[100:103], a[236:239], a[204:207], v[100:103]
    v_mfma_f32_16x16x32_bf16 v[104:107], a[236:239], a[208:211], v[104:107]
    v_mfma_f32_16x16x32_bf16 v[108:111], a[236:239], a[212:215], v[108:111]
    v_pk_mul_f32 v[24:25], v[48:49], s[70:71]
    v_pk_mul_f32 v[26:27], v[50:51], s[70:71]
    v_pk_mul_f32 v[28:29], v[52:53], s[70:71]
    v_pk_mul_f32 v[30:31], v[54:55], s[70:71]
    v_mfma_f32_16x16x32_bf16 v[112:115], a[148:151], a[112:115], v[112:115]
    v_exp_f32 v24, v24
    v_mfma_f32_16x16x32_bf16 v[116:119], a[148:151], a[116:119], v[116:119]
    v_exp_f32 v25, v25
    v_mfma_f32_16x16x32_bf16 v[120:123], a[148:151], a[120:123], v[120:123]
    v_exp_f32 v26, v26
    v_mfma_f32_16x16x32_bf16 v[124:127], a[148:151], a[124:127], v[124:127]
    v_exp_f32 v27, v27
    v_exp_f32 v28, v28
    v_exp_f32 v29, v29
    v_exp_f32 v30, v30
    v_exp_f32 v31, v31
    v_pk_mul_f32 v[80:81], v[48:49], v[80:81]
    v_pk_mul_f32 v[82:83], v[50:51], v[82:83]
    v_pk_mul_f32 v[84:85], v[52:53], v[84:85]
    v_pk_mul_f32 v[86:87], v[54:55], v[86:87]
    v_pk_add_f32 v[24:25], v[24:25], 1.0 op_sel_hi:[1,0]
    v_pk_add_f32 v[26:27], v[26:27], 1.0 op_sel_hi:[1,0]
    v_pk_add_f32 v[28:29], v[28:29], 1.0 op_sel_hi:[1,0]
    v_pk_add_f32 v[30:31], v[30:31], 1.0 op_sel_hi:[1,0]
    v_mfma_f32_16x16x32_bf16 v[128:131], a[148:151], a[128:131], v[128:131]
    v_rcp_f32 v24, v24
    v_mfma_f32_16x16x32_bf16 v[132:135], a[148:151], a[132:135], v[132:135]
    v_rcp_f32 v25, v25
    v_mfma_f32_16x16x32_bf16 v[136:139], a[148:151], a[136:139], v[136:139]
    v_rcp_f32 v26, v26
    v_mfma_f32_16x16x32_bf16 v[140:143], a[148:151], a[140:143], v[140:143]
    v_rcp_f32 v27, v27
    v_rcp_f32 v28, v28
    v_rcp_f32 v29, v29
    v_rcp_f32 v30, v30
    v_rcp_f32 v31, v31
    s_add_u32 s74, s72, 0
    v_pk_mul_f32 v[80:81], v[80:81], v[24:25]
    v_pk_mul_f32 v[82:83], v[82:83], v[26:27]
    v_pk_mul_f32 v[84:85], v[84:85], v[28:29]
    v_pk_mul_f32 v[86:87], v[86:87], v[30:31]
    v_cvt_pk_bf16_f32 v32, v80, v81
    v_cvt_pk_bf16_f32 v33, v82, v83
    v_cvt_pk_bf16_f32 v34, v84, v85
    v_cvt_pk_bf16_f32 v35, v86, v87
    s_nop 0
    v_permlane16_swap_b32 v32, v34
    v_permlane16_swap_b32 v33, v35
    buffer_store_dwordx4 v[32:35], v1, s[20:23], s74 offen sc1
    v_pk_mul_f32 v[36:37], v[56:57], s[70:71]
    v_pk_mul_f32 v[38:39], v[58:59], s[70:71]
    v_pk_mul_f32 v[40:41], v[60:61], s[70:71]
    v_pk_mul_f32 v[42:43], v[62:63], s[70:71]
    v_mfma_f32_16x16x32_bf16 v[144:147], a[168:171], a[112:115], v[144:147]
    v_exp_f32 v36, v36
    v_mfma_f32_16x16x32_bf16 v[148:151], a[168:171], a[116:119], v[148:151]
    v_exp_f32 v37, v37
    v_mfma_f32_16x16x32_bf16 v[152:155], a[168:171], a[120:123], v[152:155]
    v_exp_f32 v38, v38
    v_mfma_f32_16x16x32_bf16 v[156:159], a[168:171], a[124:127], v[156:159]
    v_exp_f32 v39, v39
    v_exp_f32 v40, v40
    v_exp_f32 v41, v41
    v_exp_f32 v42, v42
    v_exp_f32 v43, v43
    v_pk_mul_f32 v[88:89], v[56:57], v[88:89]
    v_pk_mul_f32 v[90:91], v[58:59], v[90:91]
    v_pk_mul_f32 v[92:93], v[60:61], v[92:93]
    v_pk_mul_f32 v[94:95], v[62:63], v[94:95]
    v_pk_add_f32 v[36:37], v[36:37], 1.0 op_sel_hi:[1,0]
    v_pk_add_f32 v[38:39], v[38:39], 1.0 op_sel_hi:[1,0]
    v_pk_add_f32 v[40:41], v[40:41], 1.0 op_sel_hi:[1,0]
    v_pk_add_f32 v[42:43], v[42:43], 1.0 op_sel_hi:[1,0]
    v_mfma_f32_16x16x32_bf16 v[160:163], a[168:171], a[128:131], v[160:163]
    v_rcp_f32 v36, v36
    v_mfma_f32_16x16x32_bf16 v[164:167], a[168:171], a[132:135], v[164:167]
    v_rcp_f32 v37, v37
    v_mfma_f32_16x16x32_bf16 v[168:171], a[168:171], a[136:139], v[168:171]
    v_rcp_f32 v38, v38
    v_mfma_f32_16x16x32_bf16 v[172:175], a[168:171], a[140:143], v[172:175]
    v_rcp_f32 v39, v39
    v_rcp_f32 v40, v40
    v_rcp_f32 v41, v41
    v_rcp_f32 v42, v42
    v_rcp_f32 v43, v43
    s_add_u32 s74, s72, 294912
    v_pk_mul_f32 v[88:89], v[88:89], v[36:37]
    v_pk_mul_f32 v[90:91], v[90:91], v[38:39]
    v_pk_mul_f32 v[92:93], v[92:93], v[40:41]
    v_pk_mul_f32 v[94:95], v[94:95], v[42:43]
    v_cvt_pk_bf16_f32 v44, v88, v89
    v_cvt_pk_bf16_f32 v45, v90, v91
    v_cvt_pk_bf16_f32 v46, v92, v93
    v_cvt_pk_bf16_f32 v47, v94, v95
    s_nop 0
    v_permlane16_swap_b32 v44, v46
    v_permlane16_swap_b32 v45, v47
    buffer_store_dwordx4 v[44:47], v1, s[20:23], s74 offen sc1
    v_pk_mul_f32 v[24:25], v[64:65], s[70:71]
    v_pk_mul_f32 v[26:27], v[66:67], s[70:71]
    v_pk_mul_f32 v[28:29], v[68:69], s[70:71]
    v_pk_mul_f32 v[30:31], v[70:71], s[70:71]
    v_mfma_f32_16x16x32_bf16 v[112:115], a[220:223], a[184:187], v[112:115]
    v_exp_f32 v24, v24
    v_mfma_f32_16x16x32_bf16 v[116:119], a[220:223], a[188:191], v[116:119]
    v_exp_f32 v25, v25
    v_mfma_f32_16x16x32_bf16 v[120:123], a[220:223], a[192:195], v[120:123]
    v_exp_f32 v26, v26
    v_mfma_f32_16x16x32_bf16 v[124:127], a[220:223], a[196:199], v[124:127]
    v_exp_f32 v27, v27
    v_exp_f32 v28, v28
    v_exp_f32 v29, v29
    v_exp_f32 v30, v30
    v_exp_f32 v31, v31
    v_pk_mul_f32 v[96:97], v[64:65], v[96:97]
    v_pk_mul_f32 v[98:99], v[66:67], v[98:99]
    v_pk_mul_f32 v[100:101], v[68:69], v[100:101]
    v_pk_mul_f32 v[102:103], v[70:71], v[102:103]
    v_pk_add_f32 v[24:25], v[24:25], 1.0 op_sel_hi:[1,0]
    v_pk_add_f32 v[26:27], v[26:27], 1.0 op_sel_hi:[1,0]
    v_pk_add_f32 v[28:29], v[28:29], 1.0 op_sel_hi:[1,0]
    v_pk_add_f32 v[30:31], v[30:31], 1.0 op_sel_hi:[1,0]
    v_mfma_f32_16x16x32_bf16 v[128:131], a[220:223], a[200:203], v[128:131]
    v_rcp_f32 v24, v24
    v_mfma_f32_16x16x32_bf16 v[132:135], a[220:223], a[204:207], v[132:135]
    v_rcp_f32 v25, v25
    v_mfma_f32_16x16x32_bf16 v[136:139], a[220:223], a[208:211], v[136:139]
    v_rcp_f32 v26, v26
    v_mfma_f32_16x16x32_bf16 v[140:143], a[220:223], a[212:215], v[140:143]
    v_rcp_f32 v27, v27
    v_rcp_f32 v28, v28
    v_rcp_f32 v29, v29
    v_rcp_f32 v30, v30
    v_rcp_f32 v31, v31
    s_add_u32 s74, s72, 589824
    v_pk_mul_f32 v[96:97], v[96:97], v[24:25]
    v_pk_mul_f32 v[98:99], v[98:99], v[26:27]
    v_pk_mul_f32 v[100:101], v[100:101], v[28:29]
    v_pk_mul_f32 v[102:103], v[102:103], v[30:31]
    v_cvt_pk_bf16_f32 v32, v96, v97
    v_cvt_pk_bf16_f32 v33, v98, v99
    v_cvt_pk_bf16_f32 v34, v100, v101
    v_cvt_pk_bf16_f32 v35, v102, v103
    s_nop 0
    v_permlane16_swap_b32 v32, v34
    v_permlane16_swap_b32 v33, v35
    buffer_store_dwordx4 v[32:35], v1, s[20:23], s74 offen sc1
    v_pk_mul_f32 v[36:37], v[72:73], s[70:71]
    v_pk_mul_f32 v[38:39], v[74:75], s[70:71]
    v_pk_mul_f32 v[40:41], v[76:77], s[70:71]
    v_pk_mul_f32 v[42:43], v[78:79], s[70:71]
    v_mfma_f32_16x16x32_bf16 v[144:147], a[240:243], a[184:187], v[144:147]
    v_exp_f32 v36, v36
    v_mfma_f32_16x16x32_bf16 v[148:151], a[240:243], a[188:191], v[148:151]
    v_exp_f32 v37, v37
    v_mfma_f32_16x16x32_bf16 v[152:155], a[240:243], a[192:195], v[152:155]
    v_exp_f32 v38, v38
    v_mfma_f32_16x16x32_bf16 v[156:159], a[240:243], a[196:199], v[156:159]
    v_exp_f32 v39, v39
    v_exp_f32 v40, v40
    v_exp_f32 v41, v41
    v_exp_f32 v42, v42
    v_exp_f32 v43, v43
    v_pk_mul_f32 v[104:105], v[72:73], v[104:105]
    v_pk_mul_f32 v[106:107], v[74:75], v[106:107]
    v_pk_mul_f32 v[108:109], v[76:77], v[108:109]
    v_pk_mul_f32 v[110:111], v[78:79], v[110:111]
    v_pk_add_f32 v[36:37], v[36:37], 1.0 op_sel_hi:[1,0]
    v_pk_add_f32 v[38:39], v[38:39], 1.0 op_sel_hi:[1,0]
    v_pk_add_f32 v[40:41], v[40:41], 1.0 op_sel_hi:[1,0]
    v_pk_add_f32 v[42:43], v[42:43], 1.0 op_sel_hi:[1,0]
    v_mfma_f32_16x16x32_bf16 v[160:163], a[240:243], a[200:203], v[160:163]
    v_rcp_f32 v36, v36
    v_mfma_f32_16x16x32_bf16 v[164:167], a[240:243], a[204:207], v[164:167]
    v_rcp_f32 v37, v37
    v_mfma_f32_16x16x32_bf16 v[168:171], a[240:243], a[208:211], v[168:171]
    v_rcp_f32 v38, v38
    v_mfma_f32_16x16x32_bf16 v[172:175], a[240:243], a[212:215], v[172:175]
    v_rcp_f32 v39, v39
    v_rcp_f32 v40, v40
    v_rcp_f32 v41, v41
    v_rcp_f32 v42, v42
    v_rcp_f32 v43, v43
    s_add_u32 s74, s72, 884736
    v_pk_mul_f32 v[104:105], v[104:105], v[36:37]
    v_pk_mul_f32 v[106:107], v[106:107], v[38:39]
    v_pk_mul_f32 v[108:109], v[108:109], v[40:41]
    v_pk_mul_f32 v[110:111], v[110:111], v[42:43]
    v_cvt_pk_bf16_f32 v44, v104, v105
    v_cvt_pk_bf16_f32 v45, v106, v107
    v_cvt_pk_bf16_f32 v46, v108, v109
    v_cvt_pk_bf16_f32 v47, v110, v111
    s_nop 0
    v_permlane16_swap_b32 v44, v46
    v_permlane16_swap_b32 v45, v47
    buffer_store_dwordx4 v[44:47], v1, s[20:23], s74 offen sc1
    v_pk_mul_f32 v[24:25], v[112:113], s[70:71]
    v_pk_mul_f32 v[26:27], v[114:115], s[70:71]
    v_pk_mul_f32 v[28:29], v[116:117], s[70:71]
    v_pk_mul_f32 v[30:31], v[118:119], s[70:71]
    v_mfma_f32_16x16x32_bf16 v[176:179], a[152:155], a[112:115], v[176:179]
    v_exp_f32 v24, v24
    v_mfma_f32_16x16x32_bf16 v[180:183], a[152:155], a[116:119], v[180:183]
    v_exp_f32 v25, v25
    v_mfma_f32_16x16x32_bf16 v[184:187], a[152:155], a[120:123], v[184:187]
    v_exp_f32 v26, v26
    v_mfma_f32_16x16x32_bf16 v[188:191], a[152:155], a[124:127], v[188:191]
    v_exp_f32 v27, v27
    v_exp_f32 v28, v28
    v_exp_f32 v29, v29
    v_exp_f32 v30, v30
    v_exp_f32 v31, v31
    v_pk_mul_f32 v[144:145], v[112:113], v[144:145]
    v_pk_mul_f32 v[146:147], v[114:115], v[146:147]
    v_pk_mul_f32 v[148:149], v[116:117], v[148:149]
    v_pk_mul_f32 v[150:151], v[118:119], v[150:151]
    v_pk_add_f32 v[24:25], v[24:25], 1.0 op_sel_hi:[1,0]
    v_pk_add_f32 v[26:27], v[26:27], 1.0 op_sel_hi:[1,0]
    v_pk_add_f32 v[28:29], v[28:29], 1.0 op_sel_hi:[1,0]
    v_pk_add_f32 v[30:31], v[30:31], 1.0 op_sel_hi:[1,0]
    v_mfma_f32_16x16x32_bf16 v[192:195], a[152:155], a[128:131], v[192:195]
    v_rcp_f32 v24, v24
    v_mfma_f32_16x16x32_bf16 v[196:199], a[152:155], a[132:135], v[196:199]
    v_rcp_f32 v25, v25
    v_mfma_f32_16x16x32_bf16 v[200:203], a[152:155], a[136:139], v[200:203]
    v_rcp_f32 v26, v26
    v_mfma_f32_16x16x32_bf16 v[204:207], a[152:155], a[140:143], v[204:207]
    v_rcp_f32 v27, v27
    v_rcp_f32 v28, v28
    v_rcp_f32 v29, v29
    v_rcp_f32 v30, v30
    v_rcp_f32 v31, v31
    s_add_u32 s74, s72, 2048
    v_pk_mul_f32 v[144:145], v[144:145], v[24:25]
    v_pk_mul_f32 v[146:147], v[146:147], v[26:27]
    v_pk_mul_f32 v[148:149], v[148:149], v[28:29]
    v_pk_mul_f32 v[150:151], v[150:151], v[30:31]
    v_cvt_pk_bf16_f32 v32, v144, v145
    v_cvt_pk_bf16_f32 v33, v146, v147
    v_cvt_pk_bf16_f32 v34, v148, v149
    v_cvt_pk_bf16_f32 v35, v150, v151
    s_nop 0
    v_permlane16_swap_b32 v32, v34
    v_permlane16_swap_b32 v33, v35
    buffer_store_dwordx4 v[32:35], v1, s[20:23], s74 offen sc1
    v_pk_mul_f32 v[36:37], v[120:121], s[70:71]
    v_pk_mul_f32 v[38:39], v[122:123], s[70:71]
    v_pk_mul_f32 v[40:41], v[124:125], s[70:71]
    v_pk_mul_f32 v[42:43], v[126:127], s[70:71]
    v_mfma_f32_16x16x32_bf16 v[208:211], a[172:175], a[112:115], v[208:211]
    v_exp_f32 v36, v36
    v_mfma_f32_16x16x32_bf16 v[212:215], a[172:175], a[116:119], v[212:215]
    v_exp_f32 v37, v37
    v_mfma_f32_16x16x32_bf16 v[216:219], a[172:175], a[120:123], v[216:219]
    v_exp_f32 v38, v38
    v_mfma_f32_16x16x32_bf16 v[220:223], a[172:175], a[124:127], v[220:223]
    v_exp_f32 v39, v39
    v_exp_f32 v40, v40
    v_exp_f32 v41, v41
    v_exp_f32 v42, v42
    v_exp_f32 v43, v43
    v_pk_mul_f32 v[152:153], v[120:121], v[152:153]
    v_pk_mul_f32 v[154:155], v[122:123], v[154:155]
    v_pk_mul_f32 v[156:157], v[124:125], v[156:157]
    v_pk_mul_f32 v[158:159], v[126:127], v[158:159]
    v_pk_add_f32 v[36:37], v[36:37], 1.0 op_sel_hi:[1,0]
    v_pk_add_f32 v[38:39], v[38:39], 1.0 op_sel_hi:[1,0]
    v_pk_add_f32 v[40:41], v[40:41], 1.0 op_sel_hi:[1,0]
    v_pk_add_f32 v[42:43], v[42:43], 1.0 op_sel_hi:[1,0]
    v_mfma_f32_16x16x32_bf16 v[224:227], a[172:175], a[128:131], v[224:227]
    v_rcp_f32 v36, v36
    v_mfma_f32_16x16x32_bf16 v[228:231], a[172:175], a[132:135], v[228:231]
    v_rcp_f32 v37, v37
    v_mfma_f32_16x16x32_bf16 v[232:235], a[172:175], a[136:139], v[232:235]
    v_rcp_f32 v38, v38
    v_mfma_f32_16x16x32_bf16 v[236:239], a[172:175], a[140:143], v[236:239]
    v_rcp_f32 v39, v39
    v_rcp_f32 v40, v40
    v_rcp_f32 v41, v41
    v_rcp_f32 v42, v42
    v_rcp_f32 v43, v43
    s_add_u32 s74, s72, 296960
    v_pk_mul_f32 v[152:153], v[152:153], v[36:37]
    v_pk_mul_f32 v[154:155], v[154:155], v[38:39]
    v_pk_mul_f32 v[156:157], v[156:157], v[40:41]
    v_pk_mul_f32 v[158:159], v[158:159], v[42:43]
    v_cvt_pk_bf16_f32 v44, v152, v153
    v_cvt_pk_bf16_f32 v45, v154, v155
    v_cvt_pk_bf16_f32 v46, v156, v157
    v_cvt_pk_bf16_f32 v47, v158, v159
    s_nop 0
    v_permlane16_swap_b32 v44, v46
    v_permlane16_swap_b32 v45, v47
    buffer_store_dwordx4 v[44:47], v1, s[20:23], s74 offen sc1
    v_pk_mul_f32 v[24:25], v[128:129], s[70:71]
    v_pk_mul_f32 v[26:27], v[130:131], s[70:71]
    v_pk_mul_f32 v[28:29], v[132:133], s[70:71]
    v_pk_mul_f32 v[30:31], v[134:135], s[70:71]
    v_mfma_f32_16x16x32_bf16 v[176:179], a[224:227], a[184:187], v[176:179]
    v_exp_f32 v24, v24
    v_mfma_f32_16x16x32_bf16 v[180:183], a[224:227], a[188:191], v[180:183]
    v_exp_f32 v25, v25
    v_mfma_f32_16x16x32_bf16 v[184:187], a[224:227], a[192:195], v[184:187]
    v_exp_f32 v26, v26
    v_mfma_f32_16x16x32_bf16 v[188:191], a[224:227], a[196:199], v[188:191]
    v_exp_f32 v27, v27
    v_exp_f32 v28, v28
    v_exp_f32 v29, v29
    v_exp_f32 v30, v30
    v_exp_f32 v31, v31
    v_pk_mul_f32 v[160:161], v[128:129], v[160:161]
    v_pk_mul_f32 v[162:163], v[130:131], v[162:163]
    v_pk_mul_f32 v[164:165], v[132:133], v[164:165]
    v_pk_mul_f32 v[166:167], v[134:135], v[166:167]
    v_pk_add_f32 v[24:25], v[24:25], 1.0 op_sel_hi:[1,0]
    v_pk_add_f32 v[26:27], v[26:27], 1.0 op_sel_hi:[1,0]
    v_pk_add_f32 v[28:29], v[28:29], 1.0 op_sel_hi:[1,0]
    v_pk_add_f32 v[30:31], v[30:31], 1.0 op_sel_hi:[1,0]
    v_mfma_f32_16x16x32_bf16 v[192:195], a[224:227], a[200:203], v[192:195]
    v_rcp_f32 v24, v24
    v_mfma_f32_16x16x32_bf16 v[196:199], a[224:227], a[204:207], v[196:199]
    v_rcp_f32 v25, v25
    v_mfma_f32_16x16x32_bf16 v[200:203], a[224:227], a[208:211], v[200:203]
    v_rcp_f32 v26, v26
    v_mfma_f32_16x16x32_bf16 v[204:207], a[224:227], a[212:215], v[204:207]
    v_rcp_f32 v27, v27
    v_rcp_f32 v28, v28
    v_rcp_f32 v29, v29
    v_rcp_f32 v30, v30
    v_rcp_f32 v31, v31
    s_add_u32 s74, s72, 591872
    v_pk_mul_f32 v[160:161], v[160:161], v[24:25]
    v_pk_mul_f32 v[162:163], v[162:163], v[26:27]
    v_pk_mul_f32 v[164:165], v[164:165], v[28:29]
    v_pk_mul_f32 v[166:167], v[166:167], v[30:31]
    v_cvt_pk_bf16_f32 v32, v160, v161
    v_cvt_pk_bf16_f32 v33, v162, v163
    v_cvt_pk_bf16_f32 v34, v164, v165
    v_cvt_pk_bf16_f32 v35, v166, v167
    s_nop 0
    v_permlane16_swap_b32 v32, v34
    v_permlane16_swap_b32 v33, v35
    buffer_store_dwordx4 v[32:35], v1, s[20:23], s74 offen sc1
    v_pk_mul_f32 v[36:37], v[136:137], s[70:71]
    v_pk_mul_f32 v[38:39], v[138:139], s[70:71]
    v_pk_mul_f32 v[40:41], v[140:141], s[70:71]
    v_pk_mul_f32 v[42:43], v[142:143], s[70:71]
    v_mfma_f32_16x16x32_bf16 v[208:211], a[244:247], a[184:187], v[208:211]
    v_exp_f32 v36, v36
    v_mfma_f32_16x16x32_bf16 v[212:215], a[244:247], a[188:191], v[212:215]
    v_exp_f32 v37, v37
    v_mfma_f32_16x16x32_bf16 v[216:219], a[244:247], a[192:195], v[216:219]
    v_exp_f32 v38, v38
    v_mfma_f32_16x16x32_bf16 v[220:223], a[244:247], a[196:199], v[220:223]
    v_exp_f32 v39, v39
    v_exp_f32 v40, v40
    v_exp_f32 v41, v41
    v_exp_f32 v42, v42
    v_exp_f32 v43, v43
    v_pk_mul_f32 v[168:169], v[136:137], v[168:169]
    v_pk_mul_f32 v[170:171], v[138:139], v[170:171]
    v_pk_mul_f32 v[172:173], v[140:141], v[172:173]
    v_pk_mul_f32 v[174:175], v[142:143], v[174:175]
    v_pk_add_f32 v[36:37], v[36:37], 1.0 op_sel_hi:[1,0]
    v_pk_add_f32 v[38:39], v[38:39], 1.0 op_sel_hi:[1,0]
    v_pk_add_f32 v[40:41], v[40:41], 1.0 op_sel_hi:[1,0]
    v_pk_add_f32 v[42:43], v[42:43], 1.0 op_sel_hi:[1,0]
    v_mfma_f32_16x16x32_bf16 v[224:227], a[244:247], a[200:203], v[224:227]
    v_rcp_f32 v36, v36
    v_mfma_f32_16x16x32_bf16 v[228:231], a[244:247], a[204:207], v[228:231]
    v_rcp_f32 v37, v37
    v_mfma_f32_16x16x32_bf16 v[232:235], a[244:247], a[208:211], v[232:235]
    v_rcp_f32 v38, v38
    v_mfma_f32_16x16x32_bf16 v[236:239], a[244:247], a[212:215], v[236:239]
    v_rcp_f32 v39, v39
    v_rcp_f32 v40, v40
    v_rcp_f32 v41, v41
    v_rcp_f32 v42, v42
    v_rcp_f32 v43, v43
    s_add_u32 s74, s72, 886784
    v_pk_mul_f32 v[168:169], v[168:169], v[36:37]
    v_pk_mul_f32 v[170:171], v[170:171], v[38:39]
    v_pk_mul_f32 v[172:173], v[172:173], v[40:41]
    v_pk_mul_f32 v[174:175], v[174:175], v[42:43]
    v_cvt_pk_bf16_f32 v44, v168, v169
    v_cvt_pk_bf16_f32 v45, v170, v171
    v_cvt_pk_bf16_f32 v46, v172, v173
    v_cvt_pk_bf16_f32 v47, v174, v175
    s_nop 0
    v_permlane16_swap_b32 v44, v46
    v_permlane16_swap_b32 v45, v47
    buffer_store_dwordx4 v[44:47], v1, s[20:23], s74 offen sc1
    v_pk_mul_f32 v[24:25], v[176:177], s[70:71]
    v_pk_mul_f32 v[26:27], v[178:179], s[70:71]
    v_pk_mul_f32 v[28:29], v[180:181], s[70:71]
    v_pk_mul_f32 v[30:31], v[182:183], s[70:71]
    v_mfma_f32_16x16x32_bf16 v[240:243], a[156:159], a[112:115], v[240:243]
    v_exp_f32 v24, v24
    v_mfma_f32_16x16x32_bf16 v[244:247], a[156:159], a[116:119], v[244:247]
    v_exp_f32 v25, v25
    v_mfma_f32_16x16x32_bf16 v[248:251], a[156:159], a[120:123], v[248:251]
    v_exp_f32 v26, v26
    v_mfma_f32_16x16x32_bf16 v[252:255], a[156:159], a[124:127], v[252:255]
    v_exp_f32 v27, v27
    v_exp_f32 v28, v28
    v_exp_f32 v29, v29
    v_exp_f32 v30, v30
    v_exp_f32 v31, v31
    v_pk_mul_f32 v[208:209], v[176:177], v[208:209]
    v_pk_mul_f32 v[210:211], v[178:179], v[210:211]
    v_pk_mul_f32 v[212:213], v[180:181], v[212:213]
    v_pk_mul_f32 v[214:215], v[182:183], v[214:215]
    v_pk_add_f32 v[24:25], v[24:25], 1.0 op_sel_hi:[1,0]
    v_pk_add_f32 v[26:27], v[26:27], 1.0 op_sel_hi:[1,0]
    v_pk_add_f32 v[28:29], v[28:29], 1.0 op_sel_hi:[1,0]
    v_pk_add_f32 v[30:31], v[30:31], 1.0 op_sel_hi:[1,0]
    v_mfma_f32_16x16x32_bf16 a[0:3], a[156:159], a[128:131], a[0:3]
    v_rcp_f32 v24, v24
    v_mfma_f32_16x16x32_bf16 a[4:7], a[156:159], a[132:135], a[4:7]
    v_rcp_f32 v25, v25
    v_mfma_f32_16x16x32_bf16 a[8:11], a[156:159], a[136:139], a[8:11]
    v_rcp_f32 v26, v26
    v_mfma_f32_16x16x32_bf16 a[12:15], a[156:159], a[140:143], a[12:15]
    v_rcp_f32 v27, v27
    v_rcp_f32 v28, v28
    v_rcp_f32 v29, v29
    v_rcp_f32 v30, v30
    v_rcp_f32 v31, v31
    s_add_u32 s74, s72, 4096
    v_pk_mul_f32 v[208:209], v[208:209], v[24:25]
    v_pk_mul_f32 v[210:211], v[210:211], v[26:27]
    v_pk_mul_f32 v[212:213], v[212:213], v[28:29]
    v_pk_mul_f32 v[214:215], v[214:215], v[30:31]
    v_cvt_pk_bf16_f32 v32, v208, v209
    v_cvt_pk_bf16_f32 v33, v210, v211
    v_cvt_pk_bf16_f32 v34, v212, v213
    v_cvt_pk_bf16_f32 v35, v214, v215
    s_nop 0
    v_permlane16_swap_b32 v32, v34
    v_permlane16_swap_b32 v33, v35
    buffer_store_dwordx4 v[32:35], v1, s[20:23], s74 offen sc1
    v_pk_mul_f32 v[36:37], v[184:185], s[70:71]
    v_pk_mul_f32 v[38:39], v[186:187], s[70:71]
    v_pk_mul_f32 v[40:41], v[188:189], s[70:71]
    v_pk_mul_f32 v[42:43], v[190:191], s[70:71]
    v_mfma_f32_16x16x32_bf16 a[16:19], a[176:179], a[112:115], a[16:19]
    v_exp_f32 v36, v36
    v_mfma_f32_16x16x32_bf16 a[20:23], a[176:179], a[116:119], a[20:23]
    v_exp_f32 v37, v37
    v_mfma_f32_16x16x32_bf16 a[24:27], a[176:179], a[120:123], a[24:27]
    v_exp_f32 v38, v38
    v_mfma_f32_16x16x32_bf16 a[28:31], a[176:179], a[124:127], a[28:31]
    v_exp_f32 v39, v39
    v_exp_f32 v40, v40
    v_exp_f32 v41, v41
    v_exp_f32 v42, v42
    v_exp_f32 v43, v43
    v_pk_mul_f32 v[216:217], v[184:185], v[216:217]
    v_pk_mul_f32 v[218:219], v[186:187], v[218:219]
    v_pk_mul_f32 v[220:221], v[188:189], v[220:221]
    v_pk_mul_f32 v[222:223], v[190:191], v[222:223]
    v_pk_add_f32 v[36:37], v[36:37], 1.0 op_sel_hi:[1,0]
    v_pk_add_f32 v[38:39], v[38:39], 1.0 op_sel_hi:[1,0]
    v_pk_add_f32 v[40:41], v[40:41], 1.0 op_sel_hi:[1,0]
    v_pk_add_f32 v[42:43], v[42:43], 1.0 op_sel_hi:[1,0]
    v_mfma_f32_16x16x32_bf16 a[32:35], a[176:179], a[128:131], a[32:35]
    v_rcp_f32 v36, v36
    v_mfma_f32_16x16x32_bf16 a[36:39], a[176:179], a[132:135], a[36:39]
    v_rcp_f32 v37, v37
    v_mfma_f32_16x16x32_bf16 a[40:43], a[176:179], a[136:139], a[40:43]
    v_rcp_f32 v38, v38
    v_mfma_f32_16x16x32_bf16 a[44:47], a[176:179], a[140:143], a[44:47]
    v_rcp_f32 v39, v39
    v_rcp_f32 v40, v40
    v_rcp_f32 v41, v41
    v_rcp_f32 v42, v42
    v_rcp_f32 v43, v43
    s_add_u32 s74, s72, 299008
    v_pk_mul_f32 v[216:217], v[216:217], v[36:37]
    v_pk_mul_f32 v[218:219], v[218:219], v[38:39]
    v_pk_mul_f32 v[220:221], v[220:221], v[40:41]
    v_pk_mul_f32 v[222:223], v[222:223], v[42:43]
    v_cvt_pk_bf16_f32 v44, v216, v217
    v_cvt_pk_bf16_f32 v45, v218, v219
    v_cvt_pk_bf16_f32 v46, v220, v221
    v_cvt_pk_bf16_f32 v47, v222, v223
    s_nop 0
    v_permlane16_swap_b32 v44, v46
    v_permlane16_swap_b32 v45, v47
    buffer_store_dwordx4 v[44:47], v1, s[20:23], s74 offen sc1
    v_pk_mul_f32 v[24:25], v[192:193], s[70:71]
    v_pk_mul_f32 v[26:27], v[194:195], s[70:71]
    v_pk_mul_f32 v[28:29], v[196:197], s[70:71]
    v_pk_mul_f32 v[30:31], v[198:199], s[70:71]
    v_mfma_f32_16x16x32_bf16 v[240:243], a[228:231], a[184:187], v[240:243]
    v_exp_f32 v24, v24
    v_mfma_f32_16x16x32_bf16 v[244:247], a[228:231], a[188:191], v[244:247]
    v_exp_f32 v25, v25
    v_mfma_f32_16x16x32_bf16 v[248:251], a[228:231], a[192:195], v[248:251]
    v_exp_f32 v26, v26
    v_mfma_f32_16x16x32_bf16 v[252:255], a[228:231], a[196:199], v[252:255]
    v_exp_f32 v27, v27
    v_exp_f32 v28, v28
    v_exp_f32 v29, v29
    v_exp_f32 v30, v30
    v_exp_f32 v31, v31
    v_pk_mul_f32 v[224:225], v[192:193], v[224:225]
    v_pk_mul_f32 v[226:227], v[194:195], v[226:227]
    v_pk_mul_f32 v[228:229], v[196:197], v[228:229]
    v_pk_mul_f32 v[230:231], v[198:199], v[230:231]
    v_pk_add_f32 v[24:25], v[24:25], 1.0 op_sel_hi:[1,0]
    v_pk_add_f32 v[26:27], v[26:27], 1.0 op_sel_hi:[1,0]
    v_pk_add_f32 v[28:29], v[28:29], 1.0 op_sel_hi:[1,0]
    v_pk_add_f32 v[30:31], v[30:31], 1.0 op_sel_hi:[1,0]
    v_mfma_f32_16x16x32_bf16 a[0:3], a[228:231], a[200:203], a[0:3]
    v_rcp_f32 v24, v24
    v_mfma_f32_16x16x32_bf16 a[4:7], a[228:231], a[204:207], a[4:7]
    v_rcp_f32 v25, v25
    v_mfma_f32_16x16x32_bf16 a[8:11], a[228:231], a[208:211], a[8:11]
    v_rcp_f32 v26, v26
    v_mfma_f32_16x16x32_bf16 a[12:15], a[228:231], a[212:215], a[12:15]
    v_rcp_f32 v27, v27
    v_rcp_f32 v28, v28
    v_rcp_f32 v29, v29
    v_rcp_f32 v30, v30
    v_rcp_f32 v31, v31
    s_add_u32 s74, s72, 593920
    v_pk_mul_f32 v[224:225], v[224:225], v[24:25]
    v_pk_mul_f32 v[226:227], v[226:227], v[26:27]
    v_pk_mul_f32 v[228:229], v[228:229], v[28:29]
    v_pk_mul_f32 v[230:231], v[230:231], v[30:31]
    v_cvt_pk_bf16_f32 v32, v224, v225
    v_cvt_pk_bf16_f32 v33, v226, v227
    v_cvt_pk_bf16_f32 v34, v228, v229
    v_cvt_pk_bf16_f32 v35, v230, v231
    s_nop 0
    v_permlane16_swap_b32 v32, v34
    v_permlane16_swap_b32 v33, v35
    buffer_store_dwordx4 v[32:35], v1, s[20:23], s74 offen sc1
    v_pk_mul_f32 v[36:37], v[200:201], s[70:71]
    v_pk_mul_f32 v[38:39], v[202:203], s[70:71]
    v_pk_mul_f32 v[40:41], v[204:205], s[70:71]
    v_pk_mul_f32 v[42:43], v[206:207], s[70:71]
    v_mfma_f32_16x16x32_bf16 a[16:19], a[248:251], a[184:187], a[16:19]
    v_exp_f32 v36, v36
    v_mfma_f32_16x16x32_bf16 a[20:23], a[248:251], a[188:191], a[20:23]
    v_exp_f32 v37, v37
    v_mfma_f32_16x16x32_bf16 a[24:27], a[248:251], a[192:195], a[24:27]
    v_exp_f32 v38, v38
    v_mfma_f32_16x16x32_bf16 a[28:31], a[248:251], a[196:199], a[28:31]
    v_exp_f32 v39, v39
    v_exp_f32 v40, v40
    v_exp_f32 v41, v41
    v_exp_f32 v42, v42
    v_exp_f32 v43, v43
    v_pk_mul_f32 v[232:233], v[200:201], v[232:233]
    v_pk_mul_f32 v[234:235], v[202:203], v[234:235]
    v_pk_mul_f32 v[236:237], v[204:205], v[236:237]
    v_pk_mul_f32 v[238:239], v[206:207], v[238:239]
    v_pk_add_f32 v[36:37], v[36:37], 1.0 op_sel_hi:[1,0]
    v_pk_add_f32 v[38:39], v[38:39], 1.0 op_sel_hi:[1,0]
    v_pk_add_f32 v[40:41], v[40:41], 1.0 op_sel_hi:[1,0]
    v_pk_add_f32 v[42:43], v[42:43], 1.0 op_sel_hi:[1,0]
    v_mfma_f32_16x16x32_bf16 a[32:35], a[248:251], a[200:203], a[32:35]
    v_rcp_f32 v36, v36
    v_mfma_f32_16x16x32_bf16 a[36:39], a[248:251], a[204:207], a[36:39]
    v_rcp_f32 v37, v37
    v_mfma_f32_16x16x32_bf16 a[40:43], a[248:251], a[208:211], a[40:43]
    v_rcp_f32 v38, v38
    v_mfma_f32_16x16x32_bf16 a[44:47], a[248:251], a[212:215], a[44:47]
    v_rcp_f32 v39, v39
    v_rcp_f32 v40, v40
    v_rcp_f32 v41, v41
    v_rcp_f32 v42, v42
    v_rcp_f32 v43, v43
    s_add_u32 s74, s72, 888832
    v_pk_mul_f32 v[232:233], v[232:233], v[36:37]
    v_pk_mul_f32 v[234:235], v[234:235], v[38:39]
    v_pk_mul_f32 v[236:237], v[236:237], v[40:41]
    v_pk_mul_f32 v[238:239], v[238:239], v[42:43]
    v_cvt_pk_bf16_f32 v44, v232, v233
    v_cvt_pk_bf16_f32 v45, v234, v235
    v_cvt_pk_bf16_f32 v46, v236, v237
    v_cvt_pk_bf16_f32 v47, v238, v239
    s_nop 0
    v_permlane16_swap_b32 v44, v46
    v_permlane16_swap_b32 v45, v47
    buffer_store_dwordx4 v[44:47], v1, s[20:23], s74 offen sc1
    s_cmp_eq_u32 s48, 1
    s_cbranch_scc1 k1_kernel_o3
    v_accvgpr_read_b32 v48, a16
    v_accvgpr_read_b32 v49, a17
    v_accvgpr_read_b32 v50, a18
    v_accvgpr_read_b32 v51, a19
    v_accvgpr_read_b32 v52, a20
    v_accvgpr_read_b32 v53, a21
    v_accvgpr_read_b32 v54, a22
    v_accvgpr_read_b32 v55, a23
    v_pk_mul_f32 v[24:25], v[240:241], s[70:71]
    v_pk_mul_f32 v[26:27], v[242:243], s[70:71]
    v_pk_mul_f32 v[28:29], v[244:245], s[70:71]
    v_pk_mul_f32 v[30:31], v[246:247], s[70:71]
    v_mfma_f32_16x16x32_bf16 a[48:51], a[160:163], a[112:115], a[48:51]
    v_exp_f32 v24, v24
    v_mfma_f32_16x16x32_bf16 a[52:55], a[160:163], a[116:119], a[52:55]
    v_exp_f32 v25, v25
    v_mfma_f32_16x16x32_bf16 a[56:59], a[160:163], a[120:123], a[56:59]
    v_exp_f32 v26, v26
    v_mfma_f32_16x16x32_bf16 a[60:63], a[160:163], a[124:127], a[60:63]
    v_exp_f32 v27, v27
    v_exp_f32 v28, v28
    v_exp_f32 v29, v29
    v_exp_f32 v30, v30
    v_exp_f32 v31, v31
    v_pk_mul_f32 v[48:49], v[240:241], v[48:49]
    v_pk_mul_f32 v[50:51], v[242:243], v[50:51]
    v_pk_mul_f32 v[52:53], v[244:245], v[52:53]
    v_pk_mul_f32 v[54:55], v[246:247], v[54:55]
    v_pk_add_f32 v[24:25], v[24:25], 1.0 op_sel_hi:[1,0]
    v_pk_add_f32 v[26:27], v[26:27], 1.0 op_sel_hi:[1,0]
    v_pk_add_f32 v[28:29], v[28:29], 1.0 op_sel_hi:[1,0]
    v_pk_add_f32 v[30:31], v[30:31], 1.0 op_sel_hi:[1,0]
    v_mfma_f32_16x16x32_bf16 a[64:67], a[160:163], a[128:131], a[64:67]
    v_rcp_f32 v24, v24
    v_mfma_f32_16x16x32_bf16 a[68:71], a[160:163], a[132:135], a[68:71]
    v_rcp_f32 v25, v25
    v_mfma_f32_16x16x32_bf16 a[72:75], a[160:163], a[136:139], a[72:75]
    v_rcp_f32 v26, v26
    v_mfma_f32_16x16x32_bf16 a[76:79], a[160:163], a[140:143], a[76:79]
    v_rcp_f32 v27, v27
    v_rcp_f32 v28, v28
    v_rcp_f32 v29, v29
    v_rcp_f32 v30, v30
    v_rcp_f32 v31, v31
    s_add_u32 s74, s72, 6144
    v_pk_mul_f32 v[48:49], v[48:49], v[24:25]
    v_pk_mul_f32 v[50:51], v[50:51], v[26:27]
    v_pk_mul_f32 v[52:53], v[52:53], v[28:29]
    v_pk_mul_f32 v[54:55], v[54:55], v[30:31]
    v_cvt_pk_bf16_f32 v32, v48, v49
    v_cvt_pk_bf16_f32 v33, v50, v51
    v_cvt_pk_bf16_f32 v34, v52, v53
    v_cvt_pk_bf16_f32 v35, v54, v55
    s_nop 0
    v_permlane16_swap_b32 v32, v34
    v_permlane16_swap_b32 v33, v35
    buffer_store_dwordx4 v[32:35], v1, s[20:23], s74 offen sc1
    v_accvgpr_read_b32 v48, a24
    v_accvgpr_read_b32 v49, a25
    v_accvgpr_read_b32 v50, a26
    v_accvgpr_read_b32 v51, a27
    v_accvgpr_read_b32 v52, a28
    v_accvgpr_read_b32 v53, a29
    v_accvgpr_read_b32 v54, a30
    v_accvgpr_read_b32 v55, a31
    v_pk_mul_f32 v[36:37], v[248:249], s[70:71]
    v_pk_mul_f32 v[38:39], v[250:251], s[70:71]
    v_pk_mul_f32 v[40:41], v[252:253], s[70:71]
    v_pk_mul_f32 v[42:43], v[254:255], s[70:71]
    v_mfma_f32_16x16x32_bf16 a[80:83], a[180:183], a[112:115], a[80:83]
    v_exp_f32 v36, v36
    v_mfma_f32_16x16x32_bf16 a[84:87], a[180:183], a[116:119], a[84:87]
    v_exp_f32 v37, v37
    v_mfma_f32_16x16x32_bf16 a[88:91], a[180:183], a[120:123], a[88:91]
    v_exp_f32 v38, v38
    v_mfma_f32_16x16x32_bf16 a[92:95], a[180:183], a[124:127], a[92:95]
    v_exp_f32 v39, v39
    v_exp_f32 v40, v40
    v_exp_f32 v41, v41
    v_exp_f32 v42, v42
    v_exp_f32 v43, v43
    v_pk_mul_f32 v[48:49], v[248:249], v[48:49]
    v_pk_mul_f32 v[50:51], v[250:251], v[50:51]
    v_pk_mul_f32 v[52:53], v[252:253], v[52:53]
    v_pk_mul_f32 v[54:55], v[254:255], v[54:55]
    v_pk_add_f32 v[36:37], v[36:37], 1.0 op_sel_hi:[1,0]
    v_pk_add_f32 v[38:39], v[38:39], 1.0 op_sel_hi:[1,0]
    v_pk_add_f32 v[40:41], v[40:41], 1.0 op_sel_hi:[1,0]
    v_pk_add_f32 v[42:43], v[42:43], 1.0 op_sel_hi:[1,0]
    v_mfma_f32_16x16x32_bf16 a[96:99], a[180:183], a[128:131], a[96:99]
    v_rcp_f32 v36, v36
    v_mfma_f32_16x16x32_bf16 a[100:103], a[180:183], a[132:135], a[100:103]
    v_rcp_f32 v37, v37
    v_mfma_f32_16x16x32_bf16 a[104:107], a[180:183], a[136:139], a[104:107]
    v_rcp_f32 v38, v38
    v_mfma_f32_16x16x32_bf16 a[108:111], a[180:183], a[140:143], a[108:111]
    v_rcp_f32 v39, v39
    v_rcp_f32 v40, v40
    v_rcp_f32 v41, v41
    v_rcp_f32 v42, v42
    v_rcp_f32 v43, v43
    s_add_u32 s74, s72, 301056
    v_pk_mul_f32 v[48:49], v[48:49], v[36:37]
    v_pk_mul_f32 v[50:51], v[50:51], v[38:39]
    v_pk_mul_f32 v[52:53], v[52:53], v[40:41]
    v_pk_mul_f32 v[54:55], v[54:55], v[42:43]
    v_cvt_pk_bf16_f32 v44, v48, v49
    v_cvt_pk_bf16_f32 v45, v50, v51
    v_cvt_pk_bf16_f32 v46, v52, v53
    v_cvt_pk_bf16_f32 v47, v54, v55
    s_nop 0
    v_permlane16_swap_b32 v44, v46
    v_permlane16_swap_b32 v45, v47
    buffer_store_dwordx4 v[44:47], v1, s[20:23], s74 offen sc1
    v_accvgpr_read_b32 v16, a0
    v_accvgpr_read_b32 v17, a1
    v_accvgpr_read_b32 v18, a2
    v_accvgpr_read_b32 v19, a3
    v_accvgpr_read_b32 v20, a4
    v_accvgpr_read_b32 v21, a5
    v_accvgpr_read_b32 v22, a6
    v_accvgpr_read_b32 v23, a7
    v_accvgpr_read_b32 v48, a32
    v_accvgpr_read_b32 v49, a33
    v_accvgpr_read_b32 v50, a34
    v_accvgpr_read_b32 v51, a35
    v_accvgpr_read_b32 v52, a36
    v_accvgpr_read_b32 v53, a37
    v_accvgpr_read_b32 v54, a38
    v_accvgpr_read_b32 v55, a39
    v_pk_mul_f32 v[24:25], v[16:17], s[70:71]
    v_pk_mul_f32 v[26:27], v[18:19], s[70:71]
    v_pk_mul_f32 v[28:29], v[20:21], s[70:71]
    v_pk_mul_f32 v[30:31], v[22:23], s[70:71]
    v_mfma_f32_16x16x32_bf16 a[48:51], a[232:235], a[184:187], a[48:51]
    v_exp_f32 v24, v24
    v_mfma_f32_16x16x32_bf16 a[52:55], a[232:235], a[188:191], a[52:55]
    v_exp_f32 v25, v25
    v_mfma_f32_16x16x32_bf16 a[56:59], a[232:235], a[192:195], a[56:59]
    v_exp_f32 v26, v26
    v_mfma_f32_16x16x32_bf16 a[60:63], a[232:235], a[196:199], a[60:63]
    v_exp_f32 v27, v27
    v_exp_f32 v28, v28
    v_exp_f32 v29, v29
    v_exp_f32 v30, v30
    v_exp_f32 v31, v31
    v_pk_mul_f32 v[48:49], v[16:17], v[48:49]
    v_pk_mul_f32 v[50:51], v[18:19], v[50:51]
    v_pk_mul_f32 v[52:53], v[20:21], v[52:53]
    v_pk_mul_f32 v[54:55], v[22:23], v[54:55]
    v_pk_add_f32 v[24:25], v[24:25], 1.0 op_sel_hi:[1,0]
    v_pk_add_f32 v[26:27], v[26:27], 1.0 op_sel_hi:[1,0]
    v_pk_add_f32 v[28:29], v[28:29], 1.0 op_sel_hi:[1,0]
    v_pk_add_f32 v[30:31], v[30:31], 1.0 op_sel_hi:[1,0]
    v_mfma_f32_16x16x32_bf16 a[64:67], a[232:235], a[200:203], a[64:67]
    v_rcp_f32 v24, v24
    v_mfma_f32_16x16x32_bf16 a[68:71], a[232:235], a[204:207], a[68:71]
    v_rcp_f32 v25, v25
    v_mfma_f32_16x16x32_bf16 a[72:75], a[232:235], a[208:211], a[72:75]
    v_rcp_f32 v26, v26
    v_mfma_f32_16x16x32_bf16 a[76:79], a[232:235], a[212:215], a[76:79]
    v_rcp_f32 v27, v27
    v_rcp_f32 v28, v28
    v_rcp_f32 v29, v29
    v_rcp_f32 v30, v30
    v_rcp_f32 v31, v31
    s_add_u32 s74, s72, 595968
    v_pk_mul_f32 v[48:49], v[48:49], v[24:25]
    v_pk_mul_f32 v[50:51], v[50:51], v[26:27]
    v_pk_mul_f32 v[52:53], v[52:53], v[28:29]
    v_pk_mul_f32 v[54:55], v[54:55], v[30:31]
    v_cvt_pk_bf16_f32 v32, v48, v49
    v_cvt_pk_bf16_f32 v33, v50, v51
    v_cvt_pk_bf16_f32 v34, v52, v53
    v_cvt_pk_bf16_f32 v35, v54, v55
    s_nop 0
    v_permlane16_swap_b32 v32, v34
    v_permlane16_swap_b32 v33, v35
    buffer_store_dwordx4 v[32:35], v1, s[20:23], s74 offen sc1
    v_accvgpr_read_b32 v16, a8
    v_accvgpr_read_b32 v17, a9
    v_accvgpr_read_b32 v18, a10
    v_accvgpr_read_b32 v19, a11
    v_accvgpr_read_b32 v20, a12
    v_accvgpr_read_b32 v21, a13
    v_accvgpr_read_b32 v22, a14
    v_accvgpr_read_b32 v23, a15
    v_accvgpr_read_b32 v48, a40
    v_accvgpr_read_b32 v49, a41
    v_accvgpr_read_b32 v50, a42
    v_accvgpr_read_b32 v51, a43
    v_accvgpr_read_b32 v52, a44
    v_accvgpr_read_b32 v53, a45
    v_accvgpr_read_b32 v54, a46
    v_accvgpr_read_b32 v55, a47
    v_pk_mul_f32 v[36:37], v[16:17], s[70:71]
    v_pk_mul_f32 v[38:39], v[18:19], s[70:71]
    v_pk_mul_f32 v[40:41], v[20:21], s[70:71]
    v_pk_mul_f32 v[42:43], v[22:23], s[70:71]
    v_mfma_f32_16x16x32_bf16 a[80:83], a[252:255], a[184:187], a[80:83]
    v_exp_f32 v36, v36
    v_mfma_f32_16x16x32_bf16 a[84:87], a[252:255], a[188:191], a[84:87]
    v_exp_f32 v37, v37
    v_mfma_f32_16x16x32_bf16 a[88:91], a[252:255], a[192:195], a[88:91]
    v_exp_f32 v38, v38
    v_mfma_f32_16x16x32_bf16 a[92:95], a[252:255], a[196:199], a[92:95]
    v_exp_f32 v39, v39
    v_exp_f32 v40, v40
    v_exp_f32 v41, v41
    v_exp_f32 v42, v42
    v_exp_f32 v43, v43
    v_pk_mul_f32 v[48:49], v[16:17], v[48:49]
    v_pk_mul_f32 v[50:51], v[18:19], v[50:51]
    v_pk_mul_f32 v[52:53], v[20:21], v[52:53]
    v_pk_mul_f32 v[54:55], v[22:23], v[54:55]
    v_pk_add_f32 v[36:37], v[36:37], 1.0 op_sel_hi:[1,0]
    v_pk_add_f32 v[38:39], v[38:39], 1.0 op_sel_hi:[1,0]
    v_pk_add_f32 v[40:41], v[40:41], 1.0 op_sel_hi:[1,0]
    v_pk_add_f32 v[42:43], v[42:43], 1.0 op_sel_hi:[1,0]
    v_mfma_f32_16x16x32_bf16 a[96:99], a[252:255], a[200:203], a[96:99]
    v_rcp_f32 v36, v36
    v_mfma_f32_16x16x32_bf16 a[100:103], a[252:255], a[204:207], a[100:103]
    v_rcp_f32 v37, v37
    v_mfma_f32_16x16x32_bf16 a[104:107], a[252:255], a[208:211], a[104:107]
    v_rcp_f32 v38, v38
    v_mfma_f32_16x16x32_bf16 a[108:111], a[252:255], a[212:215], a[108:111]
    v_rcp_f32 v39, v39
    v_rcp_f32 v40, v40
    v_rcp_f32 v41, v41
    v_rcp_f32 v42, v42
    v_rcp_f32 v43, v43
    s_add_u32 s74, s72, 890880
    v_pk_mul_f32 v[48:49], v[48:49], v[36:37]
    v_pk_mul_f32 v[50:51], v[50:51], v[38:39]
    v_pk_mul_f32 v[52:53], v[52:53], v[40:41]
    v_pk_mul_f32 v[54:55], v[54:55], v[42:43]
    v_cvt_pk_bf16_f32 v44, v48, v49
    v_cvt_pk_bf16_f32 v45, v50, v51
    v_cvt_pk_bf16_f32 v46, v52, v53
    v_cvt_pk_bf16_f32 v47, v54, v55
    s_nop 0
    v_permlane16_swap_b32 v44, v46
    v_permlane16_swap_b32 v45, v47
    buffer_store_dwordx4 v[44:47], v1, s[20:23], s74 offen sc1
    s_mov_b32 s76, 0x3e8293ee
    s_mov_b32 s77, s76
    s_lshl_b32 s75, s47, 12
    s_add_u32 s75, s75, s73
    v_accvgpr_read_b32 v48, a48
    v_accvgpr_read_b32 v49, a49
    v_accvgpr_read_b32 v50, a50
    v_accvgpr_read_b32 v51, a51
    v_accvgpr_read_b32 v52, a52
    v_accvgpr_read_b32 v53, a53
    v_accvgpr_read_b32 v54, a54
    v_accvgpr_read_b32 v55, a55
    v_pk_mul_f32 v[48:49], v[48:49], s[76:77]
    v_pk_mul_f32 v[50:51], v[50:51], s[76:77]
    v_pk_mul_f32 v[52:53], v[52:53], s[76:77]
    v_pk_mul_f32 v[54:55], v[54:55], s[76:77]
    s_add_u32 s74, s75, 0
    v_cvt_pk_bf16_f32 v24, v48, v49
    v_cvt_pk_bf16_f32 v25, v50, v51
    v_cvt_pk_bf16_f32 v26, v52, v53
    v_cvt_pk_bf16_f32 v27, v54, v55
    s_nop 0
    v_permlane16_swap_b32 v24, v26
    v_permlane16_swap_b32 v25, v27
    buffer_store_dwordx4 v[24:27], v1, s[20:23], s74 offen sc1
    v_accvgpr_read_b32 v56, a56
    v_accvgpr_read_b32 v57, a57
    v_accvgpr_read_b32 v58, a58
    v_accvgpr_read_b32 v59, a59
    v_accvgpr_read_b32 v60, a60
    v_accvgpr_read_b32 v61, a61
    v_accvgpr_read_b32 v62, a62
    v_accvgpr_read_b32 v63, a63
    v_pk_mul_f32 v[56:57], v[56:57], s[76:77]
    v_pk_mul_f32 v[58:59], v[58:59], s[76:77]
    v_pk_mul_f32 v[60:61], v[60:61], s[76:77]
    v_pk_mul_f32 v[62:63], v[62:63], s[76:77]
    s_add_u32 s74, s75, 1024
    v_cvt_pk_bf16_f32 v28, v56, v57
    v_cvt_pk_bf16_f32 v29, v58, v59
    v_cvt_pk_bf16_f32 v30, v60, v61
    v_cvt_pk_bf16_f32 v31, v62, v63
    s_nop 0
    v_permlane16_swap_b32 v28, v30
    v_permlane16_swap_b32 v29, v31
    buffer_store_dwordx4 v[28:31], v1, s[20:23], s74 offen sc1
    v_accvgpr_read_b32 v48, a64
    v_accvgpr_read_b32 v49, a65
    v_accvgpr_read_b32 v50, a66
    v_accvgpr_read_b32 v51, a67
    v_accvgpr_read_b32 v52, a68
    v_accvgpr_read_b32 v53, a69
    v_accvgpr_read_b32 v54, a70
    v_accvgpr_read_b32 v55, a71
    v_pk_mul_f32 v[48:49], v[48:49], s[76:77]
    v_pk_mul_f32 v[50:51], v[50:51], s[76:77]
    v_pk_mul_f32 v[52:53], v[52:53], s[76:77]
    v_pk_mul_f32 v[54:55], v[54:55], s[76:77]
    s_add_u32 s74, s75, 2048
    v_cvt_pk_bf16_f32 v32, v48, v49
    v_cvt_pk_bf16_f32 v33, v50, v51
    v_cvt_pk_bf16_f32 v34, v52, v53
    v_cvt_pk_bf16_f32 v35, v54, v55
    s_nop 0
    v_permlane16_swap_b32 v32, v34
    v_permlane16_swap_b32 v33, v35
    buffer_store_dwordx4 v[32:35], v1, s[20:23], s74 offen sc1
    v_accvgpr_read_b32 v56, a72
    v_accvgpr_read_b32 v57, a73
    v_accvgpr_read_b32 v58, a74
    v_accvgpr_read_b32 v59, a75
    v_accvgpr_read_b32 v60, a76
    v_accvgpr_read_b32 v61, a77
    v_accvgpr_read_b32 v62, a78
    v_accvgpr_read_b32 v63, a79
    v_pk_mul_f32 v[56:57], v[56:57], s[76:77]
    v_pk_mul_f32 v[58:59], v[58:59], s[76:77]
    v_pk_mul_f32 v[60:61], v[60:61], s[76:77]
    v_pk_mul_f32 v[62:63], v[62:63], s[76:77]
    s_add_u32 s74, s75, 3072
    v_cvt_pk_bf16_f32 v36, v56, v57
    v_cvt_pk_bf16_f32 v37, v58, v59
    v_cvt_pk_bf16_f32 v38, v60, v61
    v_cvt_pk_bf16_f32 v39, v62, v63
    s_nop 0
    v_permlane16_swap_b32 v36, v38
    v_permlane16_swap_b32 v37, v39
    buffer_store_dwordx4 v[36:39], v1, s[20:23], s74 offen sc1
    v_accvgpr_read_b32 v48, a80
    v_accvgpr_read_b32 v49, a81
    v_accvgpr_read_b32 v50, a82
    v_accvgpr_read_b32 v51, a83
    v_accvgpr_read_b32 v52, a84
    v_accvgpr_read_b32 v53, a85
    v_accvgpr_read_b32 v54, a86
    v_accvgpr_read_b32 v55, a87
    v_pk_mul_f32 v[48:49], v[48:49], s[76:77]
    v_pk_mul_f32 v[50:51], v[50:51], s[76:77]
    v_pk_mul_f32 v[52:53], v[52:53], s[76:77]
    v_pk_mul_f32 v[54:55], v[54:55], s[76:77]
    s_add_u32 s74, s75, 131072
    v_cvt_pk_bf16_f32 v24, v48, v49
    v_cvt_pk_bf16_f32 v25, v50, v51
    v_cvt_pk_bf16_f32 v26, v52, v53
    v_cvt_pk_bf16_f32 v27, v54, v55
    s_nop 0
    v_permlane16_swap_b32 v24, v26
    v_permlane16_swap_b32 v25, v27
    buffer_store_dwordx4 v[24:27], v1, s[20:23], s74 offen sc1
    v_accvgpr_read_b32 v56, a88
    v_accvgpr_read_b32 v57, a89
    v_accvgpr_read_b32 v58, a90
    v_accvgpr_read_b32 v59, a91
    v_accvgpr_read_b32 v60, a92
    v_accvgpr_read_b32 v61, a93
    v_accvgpr_read_b32 v62, a94
    v_accvgpr_read_b32 v63, a95
    v_pk_mul_f32 v[56:57], v[56:57], s[76:77]
    v_pk_mul_f32 v[58:59], v[58:59], s[76:77]
    v_pk_mul_f32 v[60:61], v[60:61], s[76:77]
    v_pk_mul_f32 v[62:63], v[62:63], s[76:77]
    s_add_u32 s74, s75, 132096
    v_cvt_pk_bf16_f32 v28, v56, v57
    v_cvt_pk_bf16_f32 v29, v58, v59
    v_cvt_pk_bf16_f32 v30, v60, v61
    v_cvt_pk_bf16_f32 v31, v62, v63
    s_nop 0
    v_permlane16_swap_b32 v28, v30
    v_permlane16_swap_b32 v29, v31
    buffer_store_dwordx4 v[28:31], v1, s[20:23], s74 offen sc1
    v_accvgpr_read_b32 v48, a96
    v_accvgpr_read_b32 v49, a97
    v_accvgpr_read_b32 v50, a98
    v_accvgpr_read_b32 v51, a99
    v_accvgpr_read_b32 v52, a100
    v_accvgpr_read_b32 v53, a101
    v_accvgpr_read_b32 v54, a102
    v_accvgpr_read_b32 v55, a103
    v_pk_mul_f32 v[48:49], v[48:49], s[76:77]
    v_pk_mul_f32 v[50:51], v[50:51], s[76:77]
    v_pk_mul_f32 v[52:53], v[52:53], s[76:77]
    v_pk_mul_f32 v[54:55], v[54:55], s[76:77]
    s_add_u32 s74, s75, 133120
    v_cvt_pk_bf16_f32 v32, v48, v49
    v_cvt_pk_bf16_f32 v33, v50, v51
    v_cvt_pk_bf16_f32 v34, v52, v53
    v_cvt_pk_bf16_f32 v35, v54, v55
    s_nop 0
    v_permlane16_swap_b32 v32, v34
    v_permlane16_swap_b32 v33, v35
    buffer_store_dwordx4 v[32:35], v1, s[20:23], s74 offen sc1
    v_accvgpr_read_b32 v56, a104
    v_accvgpr_read_b32 v57, a105
    v_accvgpr_read_b32 v58, a106
    v_accvgpr_read_b32 v59, a107
    v_accvgpr_read_b32 v60, a108
    v_accvgpr_read_b32 v61, a109
    v_accvgpr_read_b32 v62, a110
    v_accvgpr_read_b32 v63, a111
    v_pk_mul_f32 v[56:57], v[56:57], s[76:77]
    v_pk_mul_f32 v[58:59], v[58:59], s[76:77]
    v_pk_mul_f32 v[60:61], v[60:61], s[76:77]
    v_pk_mul_f32 v[62:63], v[62:63], s[76:77]
    s_add_u32 s74, s75, 134144
    v_cvt_pk_bf16_f32 v36, v56, v57
    v_cvt_pk_bf16_f32 v37, v58, v59
    v_cvt_pk_bf16_f32 v38, v60, v61
    v_cvt_pk_bf16_f32 v39, v62, v63
    s_nop 0
    v_permlane16_swap_b32 v36, v38
    v_permlane16_swap_b32 v37, v39
    buffer_store_dwordx4 v[36:39], v1, s[20:23], s74 offen sc1
    s_branch k1_kernel_fin
k1_kernel_o3:
    v_mfma_f32_16x16x32_bf16 a[48:51], a[160:163], a[112:115], a[48:51]
    s_mov_b32 s76, 0x3e8293ee
    s_mov_b32 s77, s76
    s_lshl_b32 s75, s46, 12
    v_mfma_f32_16x16x32_bf16 a[52:55], a[160:163], a[116:119], a[52:55]
    s_add_u32 s75, s75, s73
    s_add_u32 s74, s75, 0
    v_cvt_pk_bf16_f32 v24, v240, v241
    v_cvt_pk_bf16_f32 v25, v242, v243
    v_mfma_f32_16x16x32_bf16 a[56:59], a[160:163], a[120:123], a[56:59]
    v_cvt_pk_bf16_f32 v26, v244, v245
    v_cvt_pk_bf16_f32 v27, v246, v247
    s_nop 0
    v_permlane16_swap_b32 v24, v26
    v_mfma_f32_16x16x32_bf16 a[60:63], a[160:163], a[124:127], a[60:63]
    v_permlane16_swap_b32 v25, v27
    buffer_store_dwordx4 v[24:27], v1, s[20:23], s74 offen sc1
    s_add_u32 s74, s75, 1024
    v_cvt_pk_bf16_f32 v28, v248, v249
    v_mfma_f32_16x16x32_bf16 a[64:67], a[160:163], a[128:131], a[64:67]
    v_cvt_pk_bf16_f32 v29, v250, v251
    v_cvt_pk_bf16_f32 v30, v252, v253
    v_cvt_pk_bf16_f32 v31, v254, v255
    s_nop 0
    v_permlane16_swap_b32 v28, v30
    v_mfma_f32_16x16x32_bf16 a[68:71], a[160:163], a[132:135], a[68:71]
    v_permlane16_swap_b32 v29, v31
    buffer_store_dwordx4 v[28:31], v1, s[20:23], s74 offen sc1
    v_accvgpr_read_b32 v48, a0
    v_mfma_f32_16x16x32_bf16 a[72:75], a[160:163], a[136:139], a[72:75]
    v_accvgpr_read_b32 v49, a1
    v_accvgpr_read_b32 v50, a2
    v_accvgpr_read_b32 v51, a3
    v_accvgpr_read_b32 v52, a4
    v_mfma_f32_16x16x32_bf16 a[76:79], a[160:163], a[140:143], a[76:79]
    v_accvgpr_read_b32 v53, a5
    v_accvgpr_read_b32 v54, a6
    v_accvgpr_read_b32 v55, a7
    s_add_u32 s74, s75, 2048
    v_mfma_f32_16x16x32_bf16 a[80:83], a[180:183], a[112:115], a[80:83]
    v_cvt_pk_bf16_f32 v32, v48, v49
    v_cvt_pk_bf16_f32 v33, v50, v51
    v_cvt_pk_bf16_f32 v34, v52, v53
    v_mfma_f32_16x16x32_bf16 a[84:87], a[180:183], a[116:119], a[84:87]
    v_cvt_pk_bf16_f32 v35, v54, v55
    v_permlane16_swap_b32 v32, v34
    s_nop 0
    v_permlane16_swap_b32 v33, v35
    buffer_store_dwordx4 v[32:35], v1, s[20:23], s74 offen sc1
    v_mfma_f32_16x16x32_bf16 a[88:91], a[180:183], a[120:123], a[88:91]
    v_accvgpr_read_b32 v56, a8
    v_accvgpr_read_b32 v57, a9
    v_accvgpr_read_b32 v58, a10
    v_mfma_f32_16x16x32_bf16 a[92:95], a[180:183], a[124:127], a[92:95]
    v_accvgpr_read_b32 v59, a11
    v_accvgpr_read_b32 v60, a12
    v_accvgpr_read_b32 v61, a13
    v_accvgpr_read_b32 v62, a14
    v_mfma_f32_16x16x32_bf16 a[96:99], a[180:183], a[128:131], a[96:99]
    v_accvgpr_read_b32 v63, a15
    s_add_u32 s74, s75, 3072
    v_cvt_pk_bf16_f32 v36, v56, v57
    v_cvt_pk_bf16_f32 v37, v58, v59
    v_mfma_f32_16x16x32_bf16 a[100:103], a[180:183], a[132:135], a[100:103]
    v_cvt_pk_bf16_f32 v38, v60, v61
    v_cvt_pk_bf16_f32 v39, v62, v63
    s_nop 0
    v_permlane16_swap_b32 v36, v38
    v_mfma_f32_16x16x32_bf16 a[104:107], a[180:183], a[136:139], a[104:107]
    v_permlane16_swap_b32 v37, v39
    buffer_store_dwordx4 v[36:39], v1, s[20:23], s74 offen sc1
    v_accvgpr_read_b32 v48, a16
    v_accvgpr_read_b32 v49, a17
    v_mfma_f32_16x16x32_bf16 a[108:111], a[180:183], a[140:143], a[108:111]
    v_accvgpr_read_b32 v50, a18
    v_accvgpr_read_b32 v51, a19
    v_accvgpr_read_b32 v52, a20
    v_accvgpr_read_b32 v53, a21
    v_mfma_f32_16x16x32_bf16 a[48:51], a[232:235], a[184:187], a[48:51]
    v_accvgpr_read_b32 v54, a22
    v_accvgpr_read_b32 v55, a23
    s_add_u32 s74, s75, 131072
    v_mfma_f32_16x16x32_bf16 a[52:55], a[232:235], a[188:191], a[52:55]
    v_cvt_pk_bf16_f32 v24, v48, v49
    v_cvt_pk_bf16_f32 v25, v50, v51
    v_cvt_pk_bf16_f32 v26, v52, v53
    v_cvt_pk_bf16_f32 v27, v54, v55
    v_mfma_f32_16x16x32_bf16 a[56:59], a[232:235], a[192:195], a[56:59]
    v_permlane16_swap_b32 v24, v26
    v_permlane16_swap_b32 v25, v27
    buffer_store_dwordx4 v[24:27], v1, s[20:23], s74 offen sc1
    v_mfma_f32_16x16x32_bf16 a[60:63], a[232:235], a[196:199], a[60:63]
    v_accvgpr_read_b32 v56, a24
    v_accvgpr_read_b32 v57, a25
    v_accvgpr_read_b32 v58, a26
    v_accvgpr_read_b32 v59, a27
    v_mfma_f32_16x16x32_bf16 a[64:67], a[232:235], a[200:203], a[64:67]
    v_accvgpr_read_b32 v60, a28
    v_accvgpr_read_b32 v61, a29
    v_accvgpr_read_b32 v62, a30
    v_accvgpr_read_b32 v63, a31
    v_mfma_f32_16x16x32_bf16 a[68:71], a[232:235], a[204:207], a[68:71]
    s_add_u32 s74, s75, 132096
    v_cvt_pk_bf16_f32 v28, v56, v57
    v_cvt_pk_bf16_f32 v29, v58, v59
    v_mfma_f32_16x16x32_bf16 a[72:75], a[232:235], a[208:211], a[72:75]
    v_cvt_pk_bf16_f32 v30, v60, v61
    v_cvt_pk_bf16_f32 v31, v62, v63
    s_nop 0
    v_permlane16_swap_b32 v28, v30
    v_permlane16_swap_b32 v29, v31
    v_mfma_f32_16x16x32_bf16 a[76:79], a[232:235], a[212:215], a[76:79]
    buffer_store_dwordx4 v[28:31], v1, s[20:23], s74 offen sc1
    v_accvgpr_read_b32 v48, a32
    v_accvgpr_read_b32 v49, a33
    v_accvgpr_read_b32 v50, a34
    v_mfma_f32_16x16x32_bf16 a[80:83], a[252:255], a[184:187], a[80:83]
    v_accvgpr_read_b32 v51, a35
    v_accvgpr_read_b32 v52, a36
    v_accvgpr_read_b32 v53, a37
    v_mfma_f32_16x16x32_bf16 a[84:87], a[252:255], a[188:191], a[84:87]
    v_accvgpr_read_b32 v54, a38
    v_accvgpr_read_b32 v55, a39
    s_add_u32 s74, s75, 133120
    v_cvt_pk_bf16_f32 v32, v48, v49
    v_mfma_f32_16x16x32_bf16 a[88:91], a[252:255], a[192:195], a[88:91]
    v_cvt_pk_bf16_f32 v33, v50, v51
    v_cvt_pk_bf16_f32 v34, v52, v53
    v_cvt_pk_bf16_f32 v35, v54, v55
    v_mfma_f32_16x16x32_bf16 a[92:95], a[252:255], a[196:199], a[92:95]
    v_permlane16_swap_b32 v32, v34
    v_permlane16_swap_b32 v33, v35
    buffer_store_dwordx4 v[32:35], v1, s[20:23], s74 offen sc1
    v_accvgpr_read_b32 v56, a40
    v_mfma_f32_16x16x32_bf16 a[96:99], a[252:255], a[200:203], a[96:99]
    v_accvgpr_read_b32 v57, a41
    v_accvgpr_read_b32 v58, a42
    v_accvgpr_read_b32 v59, a43
    v_accvgpr_read_b32 v60, a44
    v_mfma_f32_16x16x32_bf16 a[100:103], a[252:255], a[204:207], a[100:103]
    v_accvgpr_read_b32 v61, a45
    v_accvgpr_read_b32 v62, a46
    v_accvgpr_read_b32 v63, a47
    v_mfma_f32_16x16x32_bf16 a[104:107], a[252:255], a[208:211], a[104:107]
    s_add_u32 s74, s75, 134144
    v_cvt_pk_bf16_f32 v36, v56, v57
    v_cvt_pk_bf16_f32 v37, v58, v59
    v_cvt_pk_bf16_f32 v38, v60, v61
    v_mfma_f32_16x16x32_bf16 a[108:111], a[252:255], a[212:215], a[108:111]
    v_cvt_pk_bf16_f32 v39, v62, v63
    v_permlane16_swap_b32 v36, v38
    s_nop 0
    v_permlane16_swap_b32 v37, v39
    buffer_store_dwordx4 v[36:39], v1, s[20:23], s74 offen sc1
    s_lshl_b32 s75, s47, 12
    s_add_u32 s75, s75, s69
    v_accvgpr_read_b32 v48, a48
    v_accvgpr_read_b32 v49, a49
    v_accvgpr_read_b32 v50, a50
    v_accvgpr_read_b32 v51, a51
    v_accvgpr_read_b32 v52, a52
    v_accvgpr_read_b32 v53, a53
    v_accvgpr_read_b32 v54, a54
    v_accvgpr_read_b32 v55, a55
    v_cvt_pk_bf16_f32 v16, v48, v49
    v_cvt_pk_bf16_f32 v17, v50, v51
    v_cvt_pk_bf16_f32 v18, v52, v53
    v_cvt_pk_bf16_f32 v19, v54, v55
    ds_write_b64 v3, v[16:17] offset:0
    ds_write_b64 v3, v[18:19] offset:512
    v_accvgpr_read_b32 v56, a56
    v_accvgpr_read_b32 v57, a57
    v_accvgpr_read_b32 v58, a58
    v_accvgpr_read_b32 v59, a59
    v_accvgpr_read_b32 v60, a60
    v_accvgpr_read_b32 v61, a61
    v_accvgpr_read_b32 v62, a62
    v_accvgpr_read_b32 v63, a63
    v_cvt_pk_bf16_f32 v20, v56, v57
    v_cvt_pk_bf16_f32 v21, v58, v59
    v_cvt_pk_bf16_f32 v22, v60, v61
    v_cvt_pk_bf16_f32 v23, v62, v63
    ds_write_b64 v3, v[20:21] offset:1024
    ds_write_b64 v3, v[22:23] offset:1536
    v_accvgpr_read_b32 v48, a64
    v_accvgpr_read_b32 v49, a65
    v_accvgpr_read_b32 v50, a66
    v_accvgpr_read_b32 v51, a67
    v_accvgpr_read_b32 v52, a68
    v_accvgpr_read_b32 v53, a69
    v_accvgpr_read_b32 v54, a70
    v_accvgpr_read_b32 v55, a71
    v_cvt_pk_bf16_f32 v16, v48, v49
    v_cvt_pk_bf16_f32 v17, v50, v51
    v_cvt_pk_bf16_f32 v18, v52, v53
    v_cvt_pk_bf16_f32 v19, v54, v55
    ds_write_b64 v3, v[16:17] offset:2048
    ds_write_b64 v3, v[18:19] offset:2560
    v_accvgpr_read_b32 v56, a72
    v_accvgpr_read_b32 v57, a73
    v_accvgpr_read_b32 v58, a74
    v_accvgpr_read_b32 v59, a75
    v_accvgpr_read_b32 v60, a76
    v_accvgpr_read_b32 v61, a77
    v_accvgpr_read_b32 v62, a78
    v_accvgpr_read_b32 v63, a79
    v_cvt_pk_bf16_f32 v20, v56, v57
    v_cvt_pk_bf16_f32 v21, v58, v59
    v_cvt_pk_bf16_f32 v22, v60, v61
    v_cvt_pk_bf16_f32 v23, v62, v63
    ds_write_b64 v3, v[20:21] offset:3072
    ds_write_b64 v3, v[22:23] offset:3584
    v_accvgpr_read_b32 v48, a80
    v_accvgpr_read_b32 v49, a81
    v_accvgpr_read_b32 v50, a82
    v_accvgpr_read_b32 v51, a83
    v_accvgpr_read_b32 v52, a84
    v_accvgpr_read_b32 v53, a85
    v_accvgpr_read_b32 v54, a86
    v_accvgpr_read_b32 v55, a87
    v_cvt_pk_bf16_f32 v16, v48, v49
    v_cvt_pk_bf16_f32 v17, v50, v51
    v_cvt_pk_bf16_f32 v18, v52, v53
    v_cvt_pk_bf16_f32 v19, v54, v55
    ds_write_b64 v3, v[16:17] offset:4096
    ds_write_b64 v3, v[18:19] offset:4608
    v_accvgpr_read_b32 v56, a88
    v_accvgpr_read_b32 v57, a89
    v_accvgpr_read_b32 v58, a90
    v_accvgpr_read_b32 v59, a91
    v_accvgpr_read_b32 v60, a92
    v_accvgpr_read_b32 v61, a93
    v_accvgpr_read_b32 v62, a94
    v_accvgpr_read_b32 v63, a95
    v_cvt_pk_bf16_f32 v20, v56, v57
    v_cvt_pk_bf16_f32 v21, v58, v59
    v_cvt_pk_bf16_f32 v22, v60, v61
    v_cvt_pk_bf16_f32 v23, v62, v63
    ds_write_b64 v3, v[20:21] offset:5120
    ds_write_b64 v3, v[22:23] offset:5632
    v_accvgpr_read_b32 v48, a96
    v_accvgpr_read_b32 v49, a97
    v_accvgpr_read_b32 v50, a98
    v_accvgpr_read_b32 v51, a99
    v_accvgpr_read_b32 v52, a100
    v_accvgpr_read_b32 v53, a101
    v_accvgpr_read_b32 v54, a102
    v_accvgpr_read_b32 v55, a103
    v_cvt_pk_bf16_f32 v16, v48, v49
    v_cvt_pk_bf16_f32 v17, v50, v51
    v_cvt_pk_bf16_f32 v18, v52, v53
    v_cvt_pk_bf16_f32 v19, v54, v55
    ds_write_b64 v3, v[16:17] offset:6144
    ds_write_b64 v3, v[18:19] offset:6656
    v_accvgpr_read_b32 v56, a104
    v_accvgpr_read_b32 v57, a105
    v_accvgpr_read_b32 v58, a106
    v_accvgpr_read_b32 v59, a107
    v_accvgpr_read_b32 v60, a108
    v_accvgpr_read_b32 v61, a109
    v_accvgpr_read_b32 v62, a110
    v_accvgpr_read_b32 v63, a111
    v_cvt_pk_bf16_f32 v20, v56, v57
    v_cvt_pk_bf16_f32 v21, v58, v59
    v_cvt_pk_bf16_f32 v22, v60, v61
    v_cvt_pk_bf16_f32 v23, v62, v63
    ds_write_b64 v3, v[20:21] offset:7168
    ds_write_b64 v3, v[22:23] offset:7680
    s_waitcnt lgkmcnt(0)
    ds_read_b64_tr_b16 v[64:65], v4 offset:0
    ds_read_b64_tr_b16 v[66:67], v4 offset:256
    ds_read_b64_tr_b16 v[68:69], v4 offset:1024
    ds_read_b64_tr_b16 v[70:71], v4 offset:1280
    ds_read_b64_tr_b16 v[72:73], v4 offset:2048
    ds_read_b64_tr_b16 v[74:75], v4 offset:2304
    ds_read_b64_tr_b16 v[76:77], v4 offset:3072
    ds_read_b64_tr_b16 v[78:79], v4 offset:3328
    ds_read_b64_tr_b16 v[80:81], v4 offset:4096
    ds_read_b64_tr_b16 v[82:83], v4 offset:4352
    ds_read_b64_tr_b16 v[84:85], v4 offset:5120
    ds_read_b64_tr_b16 v[86:87], v4 offset:5376
    ds_read_b64_tr_b16 v[88:89], v4 offset:6144
    ds_read_b64_tr_b16 v[90:91], v4 offset:6400
    ds_read_b64_tr_b16 v[92:93], v4 offset:7168
    ds_read_b64_tr_b16 v[94:95], v4 offset:7424
    s_add_u32 s74, s75, 0
    s_waitcnt lgkmcnt(14)
    buffer_store_dwordx4 v[64:67], v2, s[20:23], s74 offen sc1
    s_add_u32 s74, s75, 2048
    s_waitcnt lgkmcnt(12)
    buffer_store_dwordx4 v[68:71], v2, s[20:23], s74 offen sc1
    s_add_u32 s74, s75, 4096
    s_waitcnt lgkmcnt(10)
    buffer_store_dwordx4 v[72:75], v2, s[20:23], s74 offen sc1
    s_add_u32 s74, s75, 6144
    s_waitcnt lgkmcnt(8)
    buffer_store_dwordx4 v[76:79], v2, s[20:23], s74 offen sc1
    s_add_u32 s74, s75, 131072
    s_waitcnt lgkmcnt(6)
    buffer_store_dwordx4 v[80:83], v2, s[20:23], s74 offen sc1
    s_add_u32 s74, s75, 133120
    s_waitcnt lgkmcnt(4)
    buffer_store_dwordx4 v[84:87], v2, s[20:23], s74 offen sc1
    s_add_u32 s74, s75, 135168
    s_waitcnt lgkmcnt(2)
    buffer_store_dwordx4 v[88:91], v2, s[20:23], s74 offen sc1
    s_add_u32 s74, s75, 137216
    s_waitcnt lgkmcnt(0)
    buffer_store_dwordx4 v[92:95], v2, s[20:23], s74 offen sc1
k1_kernel_fin:
k1_kernel_end:
    s_endpgm
.section .rodata,"a"
.p2align 6
.amdhsa_kernel k1_kernel
  .amdhsa_next_free_vgpr 512
  .amdhsa_next_free_sgpr 102
  .amdhsa_accum_offset 256
  .amdhsa_group_segment_fixed_size 0
  .amdhsa_kernarg_size 88
  .amdhsa_user_sgpr_count 2
  .amdhsa_user_sgpr_kernarg_segment_ptr 1
  .amdhsa_system_sgpr_workgroup_id_x 1
.end_amdhsa_kernel
.text
.globl k2_kernel
.p2align 8
.type k2_kernel,@function
k2_kernel:
    s_cmp_ge_u32 s2, 512
    s_cbranch_scc1 k2_kernel_end
    s_cmp_ge_u32 s2, 256
    s_cbranch_scc1 k2_kernel_down
    s_load_dwordx2 s[20:21], s[0:1], 80
    v_lshrrev_b32 v8, 6, v0
    v_and_b32 v0, 63, v0
    v_readfirstlane_b32 s8, v8
    s_and_b32 s16, s2, 7
    s_lshr_b32 s17, s2, 3
    s_lshr_b32 s18, s17, 3
    s_lshl_b32 s9, s16, 2
    s_add_u32 s9, s9, s18
    s_and_b32 s17, s17, 7
    s_lshl_b32 s10, s17, 3
    s_add_u32 s10, s10, s8
    v_lshlrev_b32 v1, 4, v0
    s_and_b32 s16, s8, 1
    s_lshr_b32 s17, s8, 1
    s_lshl_b32 s11, s9, 17
    s_lshl_b32 s18, s16, 16
    s_add_u32 s11, s11, s18
    s_lshl_b32 s18, s17, 10
    s_add_u32 s11, s11, s18
    s_add_u32 s11, s11, 4194304
    s_lshl_b32 s13, s8, 10
    s_lshl_b32 s12, s9, 17
    s_add_u32 s12, s12, s13
    s_add_u32 s12, s12, 8388608
    s_waitcnt lgkmcnt(0)
    s_mov_b32 s4, s20
    s_mov_b32 s5, s21
    s_mov_b32 s6, 0x10000000
    s_mov_b32 s7, 0x20000
    s_add_u32 m0, s13, 0
    s_nop 0
    buffer_load_dwordx4 v1, s[4:7], s11 offen lds
    s_add_u32 s11, s11, 4096
    s_lshl_b32 s16, s9, 17
    s_lshl_b32 s17, s10, 10
    s_add_u32 s16, s16, s17
    s_add_u32 s17, s16, 65536
    buffer_load_dwordx4 v[16:19], v1, s[4:7], s16 offen
    buffer_load_dwordx4 v[20:23], v1, s[4:7], s17 offen
    v_and_b32 v3, 31, v0
    v_lshlrev_b32 v3, 2, v3
    s_lshl_b32 s18, s10, 7
    s_add_u32 s18, s18, 0x2200000
    s_add_u32 m0, s13, 8192
    s_nop 0
    buffer_load_dwordx4 v1, s[4:7], s12 offen lds
    s_add_u32 s12, s12, 8192
    v_bfe_u32 v8, v0, 4, 1
    v_and_b32 v9, 6, v0
    v_mov_b32 v10, 0x3f803f80
    v_cmp_eq_u32 vcc, 0, v9
    s_nop 1
    v_cndmask_b32 v24, 0, v10, vcc
    v_cndmask_b32 v25, 0, v10, vcc
    v_cmp_eq_u32 vcc, 4, v9
    s_nop 1
    v_cndmask_b32 v26, 0, v10, vcc
    v_cndmask_b32 v27, 0, v10, vcc
    v_and_b32 v9, 1, v0
    v_mul_u32_u24 v9, 0xaaaa, v9
    v_add_u32 v4, 0x4444, v9
    v_lshl_or_b32 v4, v4, 16, v4
    v_mov_b32 v28, 0
    v_mov_b32 v29, 0
    v_mov_b32 v30, 0
    v_mov_b32 v31, 0
    v_mov_b32 v32, 0
    v_mov_b32 v33, 0
    v_mov_b32 v34, 0
    v_mov_b32 v35, 0
    v_mov_b32 v36, 0
    v_mov_b32 v37, 0
    v_mov_b32 v38, 0
    v_mov_b32 v39, 0
    v_mov_b32 v40, 0
    v_mov_b32 v41, 0
    v_mov_b32 v42, 0
    v_mov_b32 v43, 0
    v_mov_b32 v44, 0
    v_mov_b32 v45, 0
    v_mov_b32 v46, 0
    v_mov_b32 v47, 0
    v_mov_b32 v96, 0
    v_mov_b32 v97, 0
    v_mov_b32 v98, 0
    v_mov_b32 v99, 0
    v_mov_b32 v100, 0
    v_mov_b32 v101, 0
    v_mov_b32 v102, 0
    v_mov_b32 v103, 0
    v_mov_b32 v112, 0
    v_mov_b32 v113, 0
    v_mov_b32 v114, 0
    v_mov_b32 v115, 0
    v_mov_b32 v116, 0
    v_mov_b32 v117, 0
    v_mov_b32 v118, 0
    v_mov_b32 v119, 0
    s_waitcnt vmcnt(0)
    s_barrier
    ds_read_b128 v[104:107], v1 offset:0
    ds_read_b128 v[108:111], v1 offset:1024
    s_add_u32 m0, s13, 16384
    s_nop 0
    buffer_load_dwordx4 v1, s[4:7], s11 offen lds
    s_add_u32 s11, s11, 4096
    s_add_u32 m0, s13, 24576
    s_nop 0
    buffer_load_dwordx4 v1, s[4:7], s12 offen lds
    s_add_u32 s12, s12, 8192
    s_waitcnt lgkmcnt(0)
    v_mfma_f32_32x32x16_bf16 v[64:79], v[104:107], v[16:19], 0
    v_mfma_f32_32x32x16_bf16 v[64:79], v[108:111], v[20:23], v[64:79]
    ds_read_b128 v[104:107], v1 offset:2048
    ds_read_b128 v[108:111], v1 offset:3072
    buffer_load_dword v2, v3, s[4:7], s18 offen
    s_add_u32 m0, s13, 32768
    s_nop 0
    buffer_load_dwordx4 v1, s[4:7], s11 offen lds
    s_add_u32 s11, s11, 4096
    s_add_u32 m0, s13, 40960
    s_nop 0
    buffer_load_dwordx4 v1, s[4:7], s12 offen lds
    s_add_u32 s12, s12, 8192
    s_nop 0
    v_max3_f32 v8, v64, v65, v66
    v_max3_f32 v9, v67, v68, v69
    v_max3_f32 v8, v8, v70, v71
    v_max3_f32 v9, v9, v72, v73
    v_max3_f32 v8, v8, v74, v75
    v_max3_f32 v9, v9, v76, v77
    v_max3_f32 v8, v8, v78, v79
    v_max_f32 v8, v8, v9
    v_mov_b32 v9, v8
    s_nop 1
    v_permlane32_swap_b32 v8, v9
    v_max_f32 v8, v8, v9
    v_sub_f32 v48, 0, v8
    v_sub_f32 v49, 0, v8
    v_sub_f32 v50, 0, v8
    v_sub_f32 v51, 0, v8
    v_sub_f32 v52, 0, v8
    v_sub_f32 v53, 0, v8
    v_sub_f32 v54, 0, v8
    v_sub_f32 v55, 0, v8
    v_sub_f32 v56, 0, v8
    v_sub_f32 v57, 0, v8
    v_sub_f32 v58, 0, v8
    v_sub_f32 v59, 0, v8
    v_sub_f32 v60, 0, v8
    v_sub_f32 v61, 0, v8
    v_sub_f32 v62, 0, v8
    v_sub_f32 v63, 0, v8
    v_sub_f32 v64, v64, v8
    v_sub_f32 v65, v65, v8
    v_sub_f32 v66, v66, v8
    v_sub_f32 v67, v67, v8
    v_sub_f32 v68, v68, v8
    v_sub_f32 v69, v69, v8
    v_sub_f32 v70, v70, v8
    v_sub_f32 v71, v71, v8
    v_sub_f32 v72, v72, v8
    v_sub_f32 v73, v73, v8
    v_sub_f32 v74, v74, v8
    v_sub_f32 v75, v75, v8
    v_sub_f32 v76, v76, v8
    v_sub_f32 v77, v77, v8
    v_sub_f32 v78, v78, v8
    v_sub_f32 v79, v79, v8
    s_mov_b32 s14, 4
    s_waitcnt lgkmcnt(0)
k2_kernel_loop:
    s_waitcnt lgkmcnt(2)
    v_mfma_f32_32x32x16_bf16 v[80:95], v[104:107], v[16:19], v[48:63]
    ds_read_b128 v[104:107], v1 offset:4096
    v_exp_f32 v64, v64
    v_exp_f32 v65, v65
    v_exp_f32 v66, v66
    v_exp_f32 v67, v67
    v_mfma_f32_32x32x16_bf16 v[32:47], v[112:115], v[96:99], v[32:47]
    ds_read_b128 v[112:115], v1 offset:8192
    v_exp_f32 v68, v68
    v_exp_f32 v69, v69
    v_exp_f32 v70, v70
    v_exp_f32 v71, v71
    v_smfmac_f32_16x16x64_bf16 v[28:31], v[24:27], v[96:103], v4
    v_cvt_pk_bf16_f32 v96, v64, v65
    v_cvt_pk_bf16_f32 v97, v66, v67
    v_cvt_pk_bf16_f32 v98, v68, v69
    v_cvt_pk_bf16_f32 v99, v70, v71
    s_waitcnt lgkmcnt(2)
    v_mfma_f32_32x32x16_bf16 v[80:95], v[108:111], v[20:23], v[80:95]
    ds_read_b128 v[108:111], v1 offset:5120
    v_exp_f32 v72, v72
    v_exp_f32 v73, v73
    v_exp_f32 v74, v74
    v_exp_f32 v75, v75
    v_mfma_f32_32x32x16_bf16 v[32:47], v[116:119], v[100:103], v[32:47]
    ds_read_b128 v[116:119], v1 offset:9216
    v_exp_f32 v76, v76
    v_exp_f32 v77, v77
    v_exp_f32 v78, v78
    v_exp_f32 v79, v79
    v_cvt_pk_bf16_f32 v100, v72, v73
    v_cvt_pk_bf16_f32 v101, v74, v75
    v_cvt_pk_bf16_f32 v102, v76, v77
    v_cvt_pk_bf16_f32 v103, v78, v79
    s_waitcnt lgkmcnt(2)
    v_mfma_f32_32x32x16_bf16 v[64:79], v[104:107], v[16:19], v[48:63]
    ds_read_b128 v[104:107], v1 offset:6144
    v_exp_f32 v80, v80
    v_exp_f32 v81, v81
    v_exp_f32 v82, v82
    v_exp_f32 v83, v83
    v_mfma_f32_32x32x16_bf16 v[32:47], v[112:115], v[96:99], v[32:47]
    ds_read_b128 v[112:115], v1 offset:10240
    v_exp_f32 v84, v84
    v_exp_f32 v85, v85
    v_exp_f32 v86, v86
    v_exp_f32 v87, v87
    v_smfmac_f32_16x16x64_bf16 v[28:31], v[24:27], v[96:103], v4
    v_cvt_pk_bf16_f32 v96, v80, v81
    v_cvt_pk_bf16_f32 v97, v82, v83
    v_cvt_pk_bf16_f32 v98, v84, v85
    v_cvt_pk_bf16_f32 v99, v86, v87
    s_waitcnt lgkmcnt(2)
    v_mfma_f32_32x32x16_bf16 v[64:79], v[108:111], v[20:23], v[64:79]
    ds_read_b128 v[108:111], v1 offset:7168
    v_exp_f32 v88, v88
    v_exp_f32 v89, v89
    v_exp_f32 v90, v90
    v_exp_f32 v91, v91
    v_mfma_f32_32x32x16_bf16 v[32:47], v[116:119], v[100:103], v[32:47]
    ds_read_b128 v[116:119], v1 offset:11264
    v_exp_f32 v92, v92
    v_exp_f32 v93, v93
    v_exp_f32 v94, v94
    v_exp_f32 v95, v95
    v_cvt_pk_bf16_f32 v100, v88, v89
    v_cvt_pk_bf16_f32 v101, v90, v91
    v_cvt_pk_bf16_f32 v102, v92, v93
    v_cvt_pk_bf16_f32 v103, v94, v95
    s_waitcnt vmcnt(2) lgkmcnt(2)
    s_barrier
    v_mfma_f32_32x32x16_bf16 v[80:95], v[104:107], v[16:19], v[48:63]
    ds_read_b128 v[104:107], v1 offset:16384
    v_exp_f32 v64, v64
    v_exp_f32 v65, v65
    s_add_u32 m0, s13, 49152
    v_exp_f32 v66, v66
    buffer_load_dwordx4 v1, s[4:7], s11 offen lds
    s_add_u32 s11, s11, 4096
    v_exp_f32 v67, v67
    v_mfma_f32_32x32x16_bf16 v[32:47], v[112:115], v[96:99], v[32:47]
    ds_read_b128 v[112:115], v1 offset:12288
    v_exp_f32 v68, v68
    v_exp_f32 v69, v69
    v_exp_f32 v70, v70
    v_exp_f32 v71, v71
    v_smfmac_f32_16x16x64_bf16 v[28:31], v[24:27], v[96:103], v4
    v_cvt_pk_bf16_f32 v96, v64, v65
    v_cvt_pk_bf16_f32 v97, v66, v67
    v_cvt_pk_bf16_f32 v98, v68, v69
    v_cvt_pk_bf16_f32 v99, v70, v71
    s_waitcnt lgkmcnt(2)
    v_mfma_f32_32x32x16_bf16 v[80:95], v[108:111], v[20:23], v[80:95]
    ds_read_b128 v[108:111], v1 offset:17408
    v_exp_f32 v72, v72
    v_exp_f32 v73, v73
    s_add_u32 m0, s13, 57344
    v_exp_f32 v74, v74
    buffer_load_dwordx4 v1, s[4:7], s12 offen lds
    s_add_u32 s12, s12, 8192
    v_exp_f32 v75, v75
    v_mfma_f32_32x32x16_bf16 v[32:47], v[116:119], v[100:103], v[32:47]
    ds_read_b128 v[116:119], v1 offset:13312
    v_exp_f32 v76, v76
    v_exp_f32 v77, v77
    v_exp_f32 v78, v78
    v_exp_f32 v79, v79
    v_cvt_pk_bf16_f32 v100, v72, v73
    v_cvt_pk_bf16_f32 v101, v74, v75
    v_cvt_pk_bf16_f32 v102, v76, v77
    v_cvt_pk_bf16_f32 v103, v78, v79
    s_waitcnt lgkmcnt(2)
    v_mfma_f32_32x32x16_bf16 v[64:79], v[104:107], v[16:19], v[48:63]
    ds_read_b128 v[104:107], v1 offset:18432
    v_exp_f32 v80, v80
    v_exp_f32 v81, v81
    v_exp_f32 v82, v82
    v_exp_f32 v83, v83
    v_mfma_f32_32x32x16_bf16 v[32:47], v[112:115], v[96:99], v[32:47]
    ds_read_b128 v[112:115], v1 offset:14336
    v_exp_f32 v84, v84
    v_exp_f32 v85, v85
    v_exp_f32 v86, v86
    v_exp_f32 v87, v87
    v_smfmac_f32_16x16x64_bf16 v[28:31], v[24:27], v[96:103], v4
    v_cvt_pk_bf16_f32 v96, v80, v81
    v_cvt_pk_bf16_f32 v97, v82, v83
    v_cvt_pk_bf16_f32 v98, v84, v85
    v_cvt_pk_bf16_f32 v99, v86, v87
    s_waitcnt lgkmcnt(2)
    v_mfma_f32_32x32x16_bf16 v[64:79], v[108:111], v[20:23], v[64:79]
    ds_read_b128 v[108:111], v1 offset:19456
    v_exp_f32 v88, v88
    v_exp_f32 v89, v89
    v_exp_f32 v90, v90
    v_exp_f32 v91, v91
    v_mfma_f32_32x32x16_bf16 v[32:47], v[116:119], v[100:103], v[32:47]
    ds_read_b128 v[116:119], v1 offset:15360
    v_exp_f32 v92, v92
    v_exp_f32 v93, v93
    v_exp_f32 v94, v94
    v_exp_f32 v95, v95
    v_cvt_pk_bf16_f32 v100, v88, v89
    v_cvt_pk_bf16_f32 v101, v90, v91
    v_cvt_pk_bf16_f32 v102, v92, v93
    v_cvt_pk_bf16_f32 v103, v94, v95
    s_waitcnt lgkmcnt(2)
    v_mfma_f32_32x32x16_bf16 v[80:95], v[104:107], v[16:19], v[48:63]
    ds_read_b128 v[104:107], v1 offset:20480
    v_exp_f32 v64, v64
    v_exp_f32 v65, v65
    v_exp_f32 v66, v66
    v_exp_f32 v67, v67
    v_mfma_f32_32x32x16_bf16 v[32:47], v[112:115], v[96:99], v[32:47]
    ds_read_b128 v[112:115], v1 offset:24576
    v_exp_f32 v68, v68
    v_exp_f32 v69, v69
    v_exp_f32 v70, v70
    v_exp_f32 v71, v71
    v_smfmac_f32_16x16x64_bf16 v[28:31], v[24:27], v[96:103], v4
    v_cvt_pk_bf16_f32 v96, v64, v65
    v_cvt_pk_bf16_f32 v97, v66, v67
    v_cvt_pk_bf16_f32 v98, v68, v69
    v_cvt_pk_bf16_f32 v99, v70, v71
    s_waitcnt lgkmcnt(2)
    v_mfma_f32_32x32x16_bf16 v[80:95], v[108:111], v[20:23], v[80:95]
    ds_read_b128 v[108:111], v1 offset:21504
    v_exp_f32 v72, v72
    v_exp_f32 v73, v73
    v_exp_f32 v74, v74
    v_exp_f32 v75, v75
    v_mfma_f32_32x32x16_bf16 v[32:47], v[116:119], v[100:103], v[32:47]
    ds_read_b128 v[116:119], v1 offset:25600
    v_exp_f32 v76, v76
    v_exp_f32 v77, v77
    v_exp_f32 v78, v78
    v_exp_f32 v79, v79
    v_cvt_pk_bf16_f32 v100, v72, v73
    v_cvt_pk_bf16_f32 v101, v74, v75
    v_cvt_pk_bf16_f32 v102, v76, v77
    v_cvt_pk_bf16_f32 v103, v78, v79
    s_waitcnt lgkmcnt(2)
    v_mfma_f32_32x32x16_bf16 v[64:79], v[104:107], v[16:19], v[48:63]
    ds_read_b128 v[104:107], v1 offset:22528
    v_exp_f32 v80, v80
    v_exp_f32 v81, v81
    v_exp_f32 v82, v82
    v_exp_f32 v83, v83
    v_mfma_f32_32x32x16_bf16 v[32:47], v[112:115], v[96:99], v[32:47]
    ds_read_b128 v[112:115], v1 offset:26624
    v_exp_f32 v84, v84
    v_exp_f32 v85, v85
    v_exp_f32 v86, v86
    v_exp_f32 v87, v87
    v_smfmac_f32_16x16x64_bf16 v[28:31], v[24:27], v[96:103], v4
    v_cvt_pk_bf16_f32 v96, v80, v81
    v_cvt_pk_bf16_f32 v97, v82, v83
    v_cvt_pk_bf16_f32 v98, v84, v85
    v_cvt_pk_bf16_f32 v99, v86, v87
    s_waitcnt lgkmcnt(2)
    v_mfma_f32_32x32x16_bf16 v[64:79], v[108:111], v[20:23], v[64:79]
    ds_read_b128 v[108:111], v1 offset:23552
    v_exp_f32 v88, v88
    v_exp_f32 v89, v89
    v_exp_f32 v90, v90
    v_exp_f32 v91, v91
    v_mfma_f32_32x32x16_bf16 v[32:47], v[116:119], v[100:103], v[32:47]
    ds_read_b128 v[116:119], v1 offset:27648
    v_exp_f32 v92, v92
    v_exp_f32 v93, v93
    v_exp_f32 v94, v94
    v_exp_f32 v95, v95
    v_cvt_pk_bf16_f32 v100, v88, v89
    v_cvt_pk_bf16_f32 v101, v90, v91
    v_cvt_pk_bf16_f32 v102, v92, v93
    v_cvt_pk_bf16_f32 v103, v94, v95
    s_waitcnt vmcnt(2) lgkmcnt(2)
    s_barrier
    v_mfma_f32_32x32x16_bf16 v[80:95], v[104:107], v[16:19], v[48:63]
    ds_read_b128 v[104:107], v1 offset:32768
    v_exp_f32 v64, v64
    v_exp_f32 v65, v65
    s_add_u32 m0, s13, 0
    v_exp_f32 v66, v66
    buffer_load_dwordx4 v1, s[4:7], s11 offen lds
    s_add_u32 s11, s11, 4096
    v_exp_f32 v67, v67
    v_mfma_f32_32x32x16_bf16 v[32:47], v[112:115], v[96:99], v[32:47]
    ds_read_b128 v[112:115], v1 offset:28672
    v_exp_f32 v68, v68
    v_exp_f32 v69, v69
    v_exp_f32 v70, v70
    v_exp_f32 v71, v71
    v_smfmac_f32_16x16x64_bf16 v[28:31], v[24:27], v[96:103], v4
    v_cvt_pk_bf16_f32 v96, v64, v65
    v_cvt_pk_bf16_f32 v97, v66, v67
    v_cvt_pk_bf16_f32 v98, v68, v69
    v_cvt_pk_bf16_f32 v99, v70, v71
    s_waitcnt lgkmcnt(2)
    v_mfma_f32_32x32x16_bf16 v[80:95], v[108:111], v[20:23], v[80:95]
    ds_read_b128 v[108:111], v1 offset:33792
    v_exp_f32 v72, v72
    v_exp_f32 v73, v73
    s_add_u32 m0, s13, 8192
    v_exp_f32 v74, v74
    buffer_load_dwordx4 v1, s[4:7], s12 offen lds
    s_add_u32 s12, s12, 8192
    v_exp_f32 v75, v75
    v_mfma_f32_32x32x16_bf16 v[32:47], v[116:119], v[100:103], v[32:47]
    ds_read_b128 v[116:119], v1 offset:29696
    v_exp_f32 v76, v76
    v_exp_f32 v77, v77
    v_exp_f32 v78, v78
    v_exp_f32 v79, v79
    v_cvt_pk_bf16_f32 v100, v72, v73
    v_cvt_pk_bf16_f32 v101, v74, v75
    v_cvt_pk_bf16_f32 v102, v76, v77
    v_cvt_pk_bf16_f32 v103, v78, v79
    s_waitcnt lgkmcnt(2)
    v_mfma_f32_32x32x16_bf16 v[64:79], v[104:107], v[16:19], v[48:63]
    ds_read_b128 v[104:107], v1 offset:34816
    v_exp_f32 v80, v80
    v_exp_f32 v81, v81
    v_exp_f32 v82, v82
    v_exp_f32 v83, v83
    v_mfma_f32_32x32x16_bf16 v[32:47], v[112:115], v[96:99], v[32:47]
    ds_read_b128 v[112:115], v1 offset:30720
    v_exp_f32 v84, v84
    v_exp_f32 v85, v85
    v_exp_f32 v86, v86
    v_exp_f32 v87, v87
    v_smfmac_f32_16x16x64_bf16 v[28:31], v[24:27], v[96:103], v4
    v_cvt_pk_bf16_f32 v96, v80, v81
    v_cvt_pk_bf16_f32 v97, v82, v83
    v_cvt_pk_bf16_f32 v98, v84, v85
    v_cvt_pk_bf16_f32 v99, v86, v87
    s_waitcnt lgkmcnt(2)
    v_mfma_f32_32x32x16_bf16 v[64:79], v[108:111], v[20:23], v[64:79]
    ds_read_b128 v[108:111], v1 offset:35840
    v_exp_f32 v88, v88
    v_exp_f32 v89, v89
    v_exp_f32 v90, v90
    v_exp_f32 v91, v91
    v_mfma_f32_32x32x16_bf16 v[32:47], v[116:119], v[100:103], v[32:47]
    ds_read_b128 v[116:119], v1 offset:31744
    v_exp_f32 v92, v92
    v_exp_f32 v93, v93
    v_exp_f32 v94, v94
    v_exp_f32 v95, v95
    v_cvt_pk_bf16_f32 v100, v88, v89
    v_cvt_pk_bf16_f32 v101, v90, v91
    v_cvt_pk_bf16_f32 v102, v92, v93
    v_cvt_pk_bf16_f32 v103, v94, v95
    s_waitcnt lgkmcnt(2)
    v_mfma_f32_32x32x16_bf16 v[80:95], v[104:107], v[16:19], v[48:63]
    ds_read_b128 v[104:107], v1 offset:36864
    v_exp_f32 v64, v64
    v_exp_f32 v65, v65
    v_exp_f32 v66, v66
    v_exp_f32 v67, v67
    v_mfma_f32_32x32x16_bf16 v[32:47], v[112:115], v[96:99], v[32:47]
    ds_read_b128 v[112:115], v1 offset:40960
    v_exp_f32 v68, v68
    v_exp_f32 v69, v69
    v_exp_f32 v70, v70
    v_exp_f32 v71, v71
    v_smfmac_f32_16x16x64_bf16 v[28:31], v[24:27], v[96:103], v4
    v_cvt_pk_bf16_f32 v96, v64, v65
    v_cvt_pk_bf16_f32 v97, v66, v67
    v_cvt_pk_bf16_f32 v98, v68, v69
    v_cvt_pk_bf16_f32 v99, v70, v71
    s_waitcnt lgkmcnt(2)
    v_mfma_f32_32x32x16_bf16 v[80:95], v[108:111], v[20:23], v[80:95]
    ds_read_b128 v[108:111], v1 offset:37888
    v_exp_f32 v72, v72
    v_exp_f32 v73, v73
    v_exp_f32 v74, v74
    v_exp_f32 v75, v75
    v_mfma_f32_32x32x16_bf16 v[32:47], v[116:119], v[100:103], v[32:47]
    ds_read_b128 v[116:119], v1 offset:41984
    v_exp_f32 v76, v76
    v_exp_f32 v77, v77
    v_exp_f32 v78, v78
    v_exp_f32 v79, v79
    v_cvt_pk_bf16_f32 v100, v72, v73
    v_cvt_pk_bf16_f32 v101, v74, v75
    v_cvt_pk_bf16_f32 v102, v76, v77
    v_cvt_pk_bf16_f32 v103, v78, v79
    s_waitcnt lgkmcnt(2)
    v_mfma_f32_32x32x16_bf16 v[64:79], v[104:107], v[16:19], v[48:63]
    ds_read_b128 v[104:107], v1 offset:38912
    v_exp_f32 v80, v80
    v_exp_f32 v81, v81
    v_exp_f32 v82, v82
    v_exp_f32 v83, v83
    v_mfma_f32_32x32x16_bf16 v[32:47], v[112:115], v[96:99], v[32:47]
    ds_read_b128 v[112:115], v1 offset:43008
    v_exp_f32 v84, v84
    v_exp_f32 v85, v85
    v_exp_f32 v86, v86
    v_exp_f32 v87, v87
    v_smfmac_f32_16x16x64_bf16 v[28:31], v[24:27], v[96:103], v4
    v_cvt_pk_bf16_f32 v96, v80, v81
    v_cvt_pk_bf16_f32 v97, v82, v83
    v_cvt_pk_bf16_f32 v98, v84, v85
    v_cvt_pk_bf16_f32 v99, v86, v87
    s_waitcnt lgkmcnt(2)
    v_mfma_f32_32x32x16_bf16 v[64:79], v[108:111], v[20:23], v[64:79]
    ds_read_b128 v[108:111], v1 offset:39936
    v_exp_f32 v88, v88
    v_exp_f32 v89, v89
    v_exp_f32 v90, v90
    v_exp_f32 v91, v91
    v_mfma_f32_32x32x16_bf16 v[32:47], v[116:119], v[100:103], v[32:47]
    ds_read_b128 v[116:119], v1 offset:44032
    v_exp_f32 v92, v92
    v_exp_f32 v93, v93
    v_exp_f32 v94, v94
    v_exp_f32 v95, v95
    v_cvt_pk_bf16_f32 v100, v88, v89
    v_cvt_pk_bf16_f32 v101, v90, v91
    v_cvt_pk_bf16_f32 v102, v92, v93
    v_cvt_pk_bf16_f32 v103, v94, v95
    s_waitcnt vmcnt(2) lgkmcnt(2)
    s_barrier
    v_mfma_f32_32x32x16_bf16 v[80:95], v[104:107], v[16:19], v[48:63]
    ds_read_b128 v[104:107], v1 offset:49152
    v_exp_f32 v64, v64
    v_exp_f32 v65, v65
    s_add_u32 m0, s13, 16384
    v_exp_f32 v66, v66
    buffer_load_dwordx4 v1, s[4:7], s11 offen lds
    s_add_u32 s11, s11, 4096
    v_exp_f32 v67, v67
    v_mfma_f32_32x32x16_bf16 v[32:47], v[112:115], v[96:99], v[32:47]
    ds_read_b128 v[112:115], v1 offset:45056
    v_exp_f32 v68, v68
    v_exp_f32 v69, v69
    v_exp_f32 v70, v70
    v_exp_f32 v71, v71
    v_smfmac_f32_16x16x64_bf16 v[28:31], v[24:27], v[96:103], v4
    v_cvt_pk_bf16_f32 v96, v64, v65
    v_cvt_pk_bf16_f32 v97, v66, v67
    v_cvt_pk_bf16_f32 v98, v68, v69
    v_cvt_pk_bf16_f32 v99, v70, v71
    s_waitcnt lgkmcnt(2)
    v_mfma_f32_32x32x16_bf16 v[80:95], v[108:111], v[20:23], v[80:95]
    ds_read_b128 v[108:111], v1 offset:50176
    v_exp_f32 v72, v72
    v_exp_f32 v73, v73
    s_add_u32 m0, s13, 24576
    v_exp_f32 v74, v74
    buffer_load_dwordx4 v1, s[4:7], s12 offen lds
    s_add_u32 s12, s12, 8192
    v_exp_f32 v75, v75
    v_mfma_f32_32x32x16_bf16 v[32:47], v[116:119], v[100:103], v[32:47]
    ds_read_b128 v[116:119], v1 offset:46080
    v_exp_f32 v76, v76
    v_exp_f32 v77, v77
    v_exp_f32 v78, v78
    v_exp_f32 v79, v79
    v_cvt_pk_bf16_f32 v100, v72, v73
    v_cvt_pk_bf16_f32 v101, v74, v75
    v_cvt_pk_bf16_f32 v102, v76, v77
    v_cvt_pk_bf16_f32 v103, v78, v79
    s_waitcnt lgkmcnt(2)
    v_mfma_f32_32x32x16_bf16 v[64:79], v[104:107], v[16:19], v[48:63]
    ds_read_b128 v[104:107], v1 offset:51200
    v_exp_f32 v80, v80
    v_exp_f32 v81, v81
    v_exp_f32 v82, v82
    v_exp_f32 v83, v83
    v_mfma_f32_32x32x16_bf16 v[32:47], v[112:115], v[96:99], v[32:47]
    ds_read_b128 v[112:115], v1 offset:47104
    v_exp_f32 v84, v84
    v_exp_f32 v85, v85
    v_exp_f32 v86, v86
    v_exp_f32 v87, v87
    v_smfmac_f32_16x16x64_bf16 v[28:31], v[24:27], v[96:103], v4
    v_cvt_pk_bf16_f32 v96, v80, v81
    v_cvt_pk_bf16_f32 v97, v82, v83
    v_cvt_pk_bf16_f32 v98, v84, v85
    v_cvt_pk_bf16_f32 v99, v86, v87
    s_waitcnt lgkmcnt(2)
    v_mfma_f32_32x32x16_bf16 v[64:79], v[108:111], v[20:23], v[64:79]
    ds_read_b128 v[108:111], v1 offset:52224
    v_exp_f32 v88, v88
    v_exp_f32 v89, v89
    v_exp_f32 v90, v90
    v_exp_f32 v91, v91
    v_mfma_f32_32x32x16_bf16 v[32:47], v[116:119], v[100:103], v[32:47]
    ds_read_b128 v[116:119], v1 offset:48128
    v_exp_f32 v92, v92
    v_exp_f32 v93, v93
    v_exp_f32 v94, v94
    v_exp_f32 v95, v95
    v_cvt_pk_bf16_f32 v100, v88, v89
    v_cvt_pk_bf16_f32 v101, v90, v91
    v_cvt_pk_bf16_f32 v102, v92, v93
    v_cvt_pk_bf16_f32 v103, v94, v95
    s_waitcnt lgkmcnt(2)
    v_mfma_f32_32x32x16_bf16 v[80:95], v[104:107], v[16:19], v[48:63]
    ds_read_b128 v[104:107], v1 offset:53248
    v_exp_f32 v64, v64
    v_exp_f32 v65, v65
    v_exp_f32 v66, v66
    v_exp_f32 v67, v67
    v_mfma_f32_32x32x16_bf16 v[32:47], v[112:115], v[96:99], v[32:47]
    ds_read_b128 v[112:115], v1 offset:57344
    v_exp_f32 v68, v68
    v_exp_f32 v69, v69
    v_exp_f32 v70, v70
    v_exp_f32 v71, v71
    v_smfmac_f32_16x16x64_bf16 v[28:31], v[24:27], v[96:103], v4
    v_cvt_pk_bf16_f32 v96, v64, v65
    v_cvt_pk_bf16_f32 v97, v66, v67
    v_cvt_pk_bf16_f32 v98, v68, v69
    v_cvt_pk_bf16_f32 v99, v70, v71
    s_waitcnt lgkmcnt(2)
    v_mfma_f32_32x32x16_bf16 v[80:95], v[108:111], v[20:23], v[80:95]
    ds_read_b128 v[108:111], v1 offset:54272
    v_exp_f32 v72, v72
    v_exp_f32 v73, v73
    v_exp_f32 v74, v74
    v_exp_f32 v75, v75
    v_mfma_f32_32x32x16_bf16 v[32:47], v[116:119], v[100:103], v[32:47]
    ds_read_b128 v[116:119], v1 offset:58368
    v_exp_f32 v76, v76
    v_exp_f32 v77, v77
    v_exp_f32 v78, v78
    v_exp_f32 v79, v79
    v_cvt_pk_bf16_f32 v100, v72, v73
    v_cvt_pk_bf16_f32 v101, v74, v75
    v_cvt_pk_bf16_f32 v102, v76, v77
    v_cvt_pk_bf16_f32 v103, v78, v79
    s_waitcnt lgkmcnt(2)
    v_mfma_f32_32x32x16_bf16 v[64:79], v[104:107], v[16:19], v[48:63]
    ds_read_b128 v[104:107], v1 offset:55296
    v_exp_f32 v80, v80
    v_exp_f32 v81, v81
    v_exp_f32 v82, v82
    v_exp_f32 v83, v83
    v_mfma_f32_32x32x16_bf16 v[32:47], v[112:115], v[96:99], v[32:47]
    ds_read_b128 v[112:115], v1 offset:59392
    v_exp_f32 v84, v84
    v_exp_f32 v85, v85
    v_exp_f32 v86, v86
    v_exp_f32 v87, v87
    v_smfmac_f32_16x16x64_bf16 v[28:31], v[24:27], v[96:103], v4
    v_cvt_pk_bf16_f32 v96, v80, v81
    v_cvt_pk_bf16_f32 v97, v82, v83
    v_cvt_pk_bf16_f32 v98, v84, v85
    v_cvt_pk_bf16_f32 v99, v86, v87
    s_waitcnt lgkmcnt(2)
    v_mfma_f32_32x32x16_bf16 v[64:79], v[108:111], v[20:23], v[64:79]
    ds_read_b128 v[108:111], v1 offset:56320
    v_exp_f32 v88, v88
    v_exp_f32 v89, v89
    v_exp_f32 v90, v90
    v_exp_f32 v91, v91
    v_mfma_f32_32x32x16_bf16 v[32:47], v[116:119], v[100:103], v[32:47]
    ds_read_b128 v[116:119], v1 offset:60416
    v_exp_f32 v92, v92
    v_exp_f32 v93, v93
    v_exp_f32 v94, v94
    v_exp_f32 v95, v95
    v_cvt_pk_bf16_f32 v100, v88, v89
    v_cvt_pk_bf16_f32 v101, v90, v91
    v_cvt_pk_bf16_f32 v102, v92, v93
    v_cvt_pk_bf16_f32 v103, v94, v95
    s_waitcnt vmcnt(2) lgkmcnt(2)
    s_barrier
    v_mfma_f32_32x32x16_bf16 v[80:95], v[104:107], v[16:19], v[48:63]
    ds_read_b128 v[104:107], v1 offset:0
    v_exp_f32 v64, v64
    v_exp_f32 v65, v65
    s_add_u32 m0, s13, 32768
    v_exp_f32 v66, v66
    buffer_load_dwordx4 v1, s[4:7], s11 offen lds
    s_add_u32 s11, s11, 4096
    v_exp_f32 v67, v67
    v_mfma_f32_32x32x16_bf16 v[32:47], v[112:115], v[96:99], v[32:47]
    ds_read_b128 v[112:115], v1 offset:61440
    v_exp_f32 v68, v68
    v_exp_f32 v69, v69
    v_exp_f32 v70, v70
    v_exp_f32 v71, v71
    v_smfmac_f32_16x16x64_bf16 v[28:31], v[24:27], v[96:103], v4
    v_cvt_pk_bf16_f32 v96, v64, v65
    v_cvt_pk_bf16_f32 v97, v66, v67
    v_cvt_pk_bf16_f32 v98, v68, v69
    v_cvt_pk_bf16_f32 v99, v70, v71
    s_waitcnt lgkmcnt(2)
    v_mfma_f32_32x32x16_bf16 v[80:95], v[108:111], v[20:23], v[80:95]
    ds_read_b128 v[108:111], v1 offset:1024
    v_exp_f32 v72, v72
    v_exp_f32 v73, v73
    s_add_u32 m0, s13, 40960
    v_exp_f32 v74, v74
    buffer_load_dwordx4 v1, s[4:7], s12 offen lds
    s_add_u32 s12, s12, 8192
    v_exp_f32 v75, v75
    v_mfma_f32_32x32x16_bf16 v[32:47], v[116:119], v[100:103], v[32:47]
    ds_read_b128 v[116:119], v1 offset:62464
    v_exp_f32 v76, v76
    v_exp_f32 v77, v77
    v_exp_f32 v78, v78
    v_exp_f32 v79, v79
    v_cvt_pk_bf16_f32 v100, v72, v73
    v_cvt_pk_bf16_f32 v101, v74, v75
    v_cvt_pk_bf16_f32 v102, v76, v77
    v_cvt_pk_bf16_f32 v103, v78, v79
    s_waitcnt lgkmcnt(2)
    v_mfma_f32_32x32x16_bf16 v[64:79], v[104:107], v[16:19], v[48:63]
    ds_read_b128 v[104:107], v1 offset:2048
    v_exp_f32 v80, v80
    v_exp_f32 v81, v81
    v_exp_f32 v82, v82
    v_exp_f32 v83, v83
    v_mfma_f32_32x32x16_bf16 v[32:47], v[112:115], v[96:99], v[32:47]
    ds_read_b128 v[112:115], v1 offset:63488
    v_exp_f32 v84, v84
    v_exp_f32 v85, v85
    v_exp_f32 v86, v86
    v_exp_f32 v87, v87
    v_smfmac_f32_16x16x64_bf16 v[28:31], v[24:27], v[96:103], v4
    v_cvt_pk_bf16_f32 v96, v80, v81
    v_cvt_pk_bf16_f32 v97, v82, v83
    v_cvt_pk_bf16_f32 v98, v84, v85
    v_cvt_pk_bf16_f32 v99, v86, v87
    s_waitcnt lgkmcnt(2)
    v_mfma_f32_32x32x16_bf16 v[64:79], v[108:111], v[20:23], v[64:79]
    ds_read_b128 v[108:111], v1 offset:3072
    v_exp_f32 v88, v88
    v_exp_f32 v89, v89
    v_exp_f32 v90, v90
    v_exp_f32 v91, v91
    v_mfma_f32_32x32x16_bf16 v[32:47], v[116:119], v[100:103], v[32:47]
    ds_read_b128 v[116:119], v1 offset:64512
    v_exp_f32 v92, v92
    v_exp_f32 v93, v93
    v_exp_f32 v94, v94
    v_exp_f32 v95, v95
    v_cvt_pk_bf16_f32 v100, v88, v89
    v_cvt_pk_bf16_f32 v101, v90, v91
    v_cvt_pk_bf16_f32 v102, v92, v93
    v_cvt_pk_bf16_f32 v103, v94, v95
    s_sub_u32 s14, s14, 1
    s_cmp_lg_u32 s14, 1
    s_cbranch_scc1 k2_kernel_loop
    s_waitcnt lgkmcnt(2)
    v_mfma_f32_32x32x16_bf16 v[80:95], v[104:107], v[16:19], v[48:63]
    ds_read_b128 v[104:107], v1 offset:4096
    v_exp_f32 v64, v64
    v_exp_f32 v65, v65
    v_exp_f32 v66, v66
    v_exp_f32 v67, v67
    v_mfma_f32_32x32x16_bf16 v[32:47], v[112:115], v[96:99], v[32:47]
    ds_read_b128 v[112:115], v1 offset:8192
    v_exp_f32 v68, v68
    v_exp_f32 v69, v69
    v_exp_f32 v70, v70
    v_exp_f32 v71, v71
    v_smfmac_f32_16x16x64_bf16 v[28:31], v[24:27], v[96:103], v4
    v_cvt_pk_bf16_f32 v96, v64, v65
    v_cvt_pk_bf16_f32 v97, v66, v67
    v_cvt_pk_bf16_f32 v98, v68, v69
    v_cvt_pk_bf16_f32 v99, v70, v71
    s_waitcnt lgkmcnt(2)
    v_mfma_f32_32x32x16_bf16 v[80:95], v[108:111], v[20:23], v[80:95]
    ds_read_b128 v[108:111], v1 offset:5120
    v_exp_f32 v72, v72
    v_exp_f32 v73, v73
    v_exp_f32 v74, v74
    v_exp_f32 v75, v75
    v_mfma_f32_32x32x16_bf16 v[32:47], v[116:119], v[100:103], v[32:47]
    ds_read_b128 v[116:119], v1 offset:9216
    v_exp_f32 v76, v76
    v_exp_f32 v77, v77
    v_exp_f32 v78, v78
    v_exp_f32 v79, v79
    v_cvt_pk_bf16_f32 v100, v72, v73
    v_cvt_pk_bf16_f32 v101, v74, v75
    v_cvt_pk_bf16_f32 v102, v76, v77
    v_cvt_pk_bf16_f32 v103, v78, v79
    s_waitcnt lgkmcnt(2)
    v_mfma_f32_32x32x16_bf16 v[64:79], v[104:107], v[16:19], v[48:63]
    ds_read_b128 v[104:107], v1 offset:6144
    v_exp_f32 v80, v80
    v_exp_f32 v81, v81
    v_exp_f32 v82, v82
    v_exp_f32 v83, v83
    v_mfma_f32_32x32x16_bf16 v[32:47], v[112:115], v[96:99], v[32:47]
    ds_read_b128 v[112:115], v1 offset:10240
    v_exp_f32 v84, v84
    v_exp_f32 v85, v85
    v_exp_f32 v86, v86
    v_exp_f32 v87, v87
    v_smfmac_f32_16x16x64_bf16 v[28:31], v[24:27], v[96:103], v4
    v_cvt_pk_bf16_f32 v96, v80, v81
    v_cvt_pk_bf16_f32 v97, v82, v83
    v_cvt_pk_bf16_f32 v98, v84, v85
    v_cvt_pk_bf16_f32 v99, v86, v87
    s_waitcnt lgkmcnt(2)
    v_mfma_f32_32x32x16_bf16 v[64:79], v[108:111], v[20:23], v[64:79]
    ds_read_b128 v[108:111], v1 offset:7168
    v_exp_f32 v88, v88
    v_exp_f32 v89, v89
    v_exp_f32 v90, v90
    v_exp_f32 v91, v91
    v_mfma_f32_32x32x16_bf16 v[32:47], v[116:119], v[100:103], v[32:47]
    ds_read_b128 v[116:119], v1 offset:11264
    v_exp_f32 v92, v92
    v_exp_f32 v93, v93
    v_exp_f32 v94, v94
    v_exp_f32 v95, v95
    v_cvt_pk_bf16_f32 v100, v88, v89
    v_cvt_pk_bf16_f32 v101, v90, v91
    v_cvt_pk_bf16_f32 v102, v92, v93
    v_cvt_pk_bf16_f32 v103, v94, v95
    s_waitcnt vmcnt(2) lgkmcnt(2)
    s_barrier
    v_mfma_f32_32x32x16_bf16 v[80:95], v[104:107], v[16:19], v[48:63]
    ds_read_b128 v[104:107], v1 offset:16384
    v_exp_f32 v64, v64
    v_exp_f32 v65, v65
    s_add_u32 m0, s13, 49152
    v_exp_f32 v66, v66
    buffer_load_dwordx4 v1, s[4:7], s11 offen lds
    s_add_u32 s11, s11, 4096
    v_exp_f32 v67, v67
    v_mfma_f32_32x32x16_bf16 v[32:47], v[112:115], v[96:99], v[32:47]
    ds_read_b128 v[112:115], v1 offset:12288
    v_exp_f32 v68, v68
    v_exp_f32 v69, v69
    v_exp_f32 v70, v70
    v_exp_f32 v71, v71
    v_smfmac_f32_16x16x64_bf16 v[28:31], v[24:27], v[96:103], v4
    v_cvt_pk_bf16_f32 v96, v64, v65
    v_cvt_pk_bf16_f32 v97, v66, v67
    v_cvt_pk_bf16_f32 v98, v68, v69
    v_cvt_pk_bf16_f32 v99, v70, v71
    s_waitcnt lgkmcnt(2)
    v_mfma_f32_32x32x16_bf16 v[80:95], v[108:111], v[20:23], v[80:95]
    ds_read_b128 v[108:111], v1 offset:17408
    v_exp_f32 v72, v72
    v_exp_f32 v73, v73
    s_add_u32 m0, s13, 57344
    v_exp_f32 v74, v74
    buffer_load_dwordx4 v1, s[4:7], s12 offen lds
    s_add_u32 s12, s12, 8192
    v_exp_f32 v75, v75
    v_mfma_f32_32x32x16_bf16 v[32:47], v[116:119], v[100:103], v[32:47]
    ds_read_b128 v[116:119], v1 offset:13312
    v_exp_f32 v76, v76
    v_exp_f32 v77, v77
    v_exp_f32 v78, v78
    v_exp_f32 v79, v79
    v_cvt_pk_bf16_f32 v100, v72, v73
    v_cvt_pk_bf16_f32 v101, v74, v75
    v_cvt_pk_bf16_f32 v102, v76, v77
    v_cvt_pk_bf16_f32 v103, v78, v79
    s_waitcnt lgkmcnt(2)
    v_mfma_f32_32x32x16_bf16 v[64:79], v[104:107], v[16:19], v[48:63]
    ds_read_b128 v[104:107], v1 offset:18432
    v_exp_f32 v80, v80
    v_exp_f32 v81, v81
    v_exp_f32 v82, v82
    v_exp_f32 v83, v83
    v_mfma_f32_32x32x16_bf16 v[32:47], v[112:115], v[96:99], v[32:47]
    ds_read_b128 v[112:115], v1 offset:14336
    v_exp_f32 v84, v84
    v_exp_f32 v85, v85
    v_exp_f32 v86, v86
    v_exp_f32 v87, v87
    v_smfmac_f32_16x16x64_bf16 v[28:31], v[24:27], v[96:103], v4
    v_cvt_pk_bf16_f32 v96, v80, v81
    v_cvt_pk_bf16_f32 v97, v82, v83
    v_cvt_pk_bf16_f32 v98, v84, v85
    v_cvt_pk_bf16_f32 v99, v86, v87
    s_waitcnt lgkmcnt(2)
    v_mfma_f32_32x32x16_bf16 v[64:79], v[108:111], v[20:23], v[64:79]
    ds_read_b128 v[108:111], v1 offset:19456
    v_exp_f32 v88, v88
    v_exp_f32 v89, v89
    v_exp_f32 v90, v90
    v_exp_f32 v91, v91
    v_mfma_f32_32x32x16_bf16 v[32:47], v[116:119], v[100:103], v[32:47]
    ds_read_b128 v[116:119], v1 offset:15360
    v_exp_f32 v92, v92
    v_exp_f32 v93, v93
    v_exp_f32 v94, v94
    v_exp_f32 v95, v95
    v_cvt_pk_bf16_f32 v100, v88, v89
    v_cvt_pk_bf16_f32 v101, v90, v91
    v_cvt_pk_bf16_f32 v102, v92, v93
    v_cvt_pk_bf16_f32 v103, v94, v95
    s_waitcnt lgkmcnt(2)
    v_mfma_f32_32x32x16_bf16 v[80:95], v[104:107], v[16:19], v[48:63]
    ds_read_b128 v[104:107], v1 offset:20480
    v_exp_f32 v64, v64
    v_exp_f32 v65, v65
    v_exp_f32 v66, v66
    v_exp_f32 v67, v67
    v_mfma_f32_32x32x16_bf16 v[32:47], v[112:115], v[96:99], v[32:47]
    ds_read_b128 v[112:115], v1 offset:24576
    v_exp_f32 v68, v68
    v_exp_f32 v69, v69
    v_exp_f32 v70, v70
    v_exp_f32 v71, v71
    v_smfmac_f32_16x16x64_bf16 v[28:31], v[24:27], v[96:103], v4
    v_cvt_pk_bf16_f32 v96, v64, v65
    v_cvt_pk_bf16_f32 v97, v66, v67
    v_cvt_pk_bf16_f32 v98, v68, v69
    v_cvt_pk_bf16_f32 v99, v70, v71
    s_waitcnt lgkmcnt(2)
    v_mfma_f32_32x32x16_bf16 v[80:95], v[108:111], v[20:23], v[80:95]
    ds_read_b128 v[108:111], v1 offset:21504
    v_exp_f32 v72, v72
    v_exp_f32 v73, v73
    v_exp_f32 v74, v74
    v_exp_f32 v75, v75
    v_mfma_f32_32x32x16_bf16 v[32:47], v[116:119], v[100:103], v[32:47]
    ds_read_b128 v[116:119], v1 offset:25600
    v_exp_f32 v76, v76
    v_exp_f32 v77, v77
    v_exp_f32 v78, v78
    v_exp_f32 v79, v79
    v_cvt_pk_bf16_f32 v100, v72, v73
    v_cvt_pk_bf16_f32 v101, v74, v75
    v_cvt_pk_bf16_f32 v102, v76, v77
    v_cvt_pk_bf16_f32 v103, v78, v79
    s_waitcnt lgkmcnt(2)
    v_mfma_f32_32x32x16_bf16 v[64:79], v[104:107], v[16:19], v[48:63]
    ds_read_b128 v[104:107], v1 offset:22528
    v_exp_f32 v80, v80
    v_exp_f32 v81, v81
    v_exp_f32 v82, v82
    v_exp_f32 v83, v83
    v_mfma_f32_32x32x16_bf16 v[32:47], v[112:115], v[96:99], v[32:47]
    ds_read_b128 v[112:115], v1 offset:26624
    v_exp_f32 v84, v84
    v_exp_f32 v85, v85
    v_exp_f32 v86, v86
    v_exp_f32 v87, v87
    v_smfmac_f32_16x16x64_bf16 v[28:31], v[24:27], v[96:103], v4
    v_cvt_pk_bf16_f32 v96, v80, v81
    v_cvt_pk_bf16_f32 v97, v82, v83
    v_cvt_pk_bf16_f32 v98, v84, v85
    v_cvt_pk_bf16_f32 v99, v86, v87
    s_waitcnt lgkmcnt(2)
    v_mfma_f32_32x32x16_bf16 v[64:79], v[108:111], v[20:23], v[64:79]
    ds_read_b128 v[108:111], v1 offset:23552
    v_exp_f32 v88, v88
    v_exp_f32 v89, v89
    v_exp_f32 v90, v90
    v_exp_f32 v91, v91
    v_mfma_f32_32x32x16_bf16 v[32:47], v[116:119], v[100:103], v[32:47]
    ds_read_b128 v[116:119], v1 offset:27648
    v_exp_f32 v92, v92
    v_exp_f32 v93, v93
    v_exp_f32 v94, v94
    v_exp_f32 v95, v95
    v_cvt_pk_bf16_f32 v100, v88, v89
    v_cvt_pk_bf16_f32 v101, v90, v91
    v_cvt_pk_bf16_f32 v102, v92, v93
    v_cvt_pk_bf16_f32 v103, v94, v95
    s_waitcnt vmcnt(2) lgkmcnt(2)
    s_barrier
    v_mfma_f32_32x32x16_bf16 v[80:95], v[104:107], v[16:19], v[48:63]
    ds_read_b128 v[104:107], v1 offset:32768
    v_exp_f32 v64, v64
    v_exp_f32 v65, v65
    v_exp_f32 v66, v66
    v_exp_f32 v67, v67
    v_mfma_f32_32x32x16_bf16 v[32:47], v[112:115], v[96:99], v[32:47]
    ds_read_b128 v[112:115], v1 offset:28672
    v_exp_f32 v68, v68
    v_exp_f32 v69, v69
    v_exp_f32 v70, v70
    v_exp_f32 v71, v71
    v_smfmac_f32_16x16x64_bf16 v[28:31], v[24:27], v[96:103], v4
    v_cvt_pk_bf16_f32 v96, v64, v65
    v_cvt_pk_bf16_f32 v97, v66, v67
    v_cvt_pk_bf16_f32 v98, v68, v69
    v_cvt_pk_bf16_f32 v99, v70, v71
    s_waitcnt lgkmcnt(2)
    v_mfma_f32_32x32x16_bf16 v[80:95], v[108:111], v[20:23], v[80:95]
    ds_read_b128 v[108:111], v1 offset:33792
    v_exp_f32 v72, v72
    v_exp_f32 v73, v73
    v_exp_f32 v74, v74
    v_exp_f32 v75, v75
    v_mfma_f32_32x32x16_bf16 v[32:47], v[116:119], v[100:103], v[32:47]
    ds_read_b128 v[116:119], v1 offset:29696
    v_exp_f32 v76, v76
    v_exp_f32 v77, v77
    v_exp_f32 v78, v78
    v_exp_f32 v79, v79
    v_cvt_pk_bf16_f32 v100, v72, v73
    v_cvt_pk_bf16_f32 v101, v74, v75
    v_cvt_pk_bf16_f32 v102, v76, v77
    v_cvt_pk_bf16_f32 v103, v78, v79
    s_waitcnt lgkmcnt(2)
    v_mfma_f32_32x32x16_bf16 v[64:79], v[104:107], v[16:19], v[48:63]
    ds_read_b128 v[104:107], v1 offset:34816
    v_exp_f32 v80, v80
    v_exp_f32 v81, v81
    v_exp_f32 v82, v82
    v_exp_f32 v83, v83
    v_mfma_f32_32x32x16_bf16 v[32:47], v[112:115], v[96:99], v[32:47]
    ds_read_b128 v[112:115], v1 offset:30720
    v_exp_f32 v84, v84
    v_exp_f32 v85, v85
    v_exp_f32 v86, v86
    v_exp_f32 v87, v87
    v_smfmac_f32_16x16x64_bf16 v[28:31], v[24:27], v[96:103], v4
    v_cvt_pk_bf16_f32 v96, v80, v81
    v_cvt_pk_bf16_f32 v97, v82, v83
    v_cvt_pk_bf16_f32 v98, v84, v85
    v_cvt_pk_bf16_f32 v99, v86, v87
    s_waitcnt lgkmcnt(2)
    v_mfma_f32_32x32x16_bf16 v[64:79], v[108:111], v[20:23], v[64:79]
    ds_read_b128 v[108:111], v1 offset:35840
    v_exp_f32 v88, v88
    v_exp_f32 v89, v89
    v_exp_f32 v90, v90
    v_exp_f32 v91, v91
    v_mfma_f32_32x32x16_bf16 v[32:47], v[116:119], v[100:103], v[32:47]
    ds_read_b128 v[116:119], v1 offset:31744
    v_exp_f32 v92, v92
    v_exp_f32 v93, v93
    v_exp_f32 v94, v94
    v_exp_f32 v95, v95
    v_cvt_pk_bf16_f32 v100, v88, v89
    v_cvt_pk_bf16_f32 v101, v90, v91
    v_cvt_pk_bf16_f32 v102, v92, v93
    v_cvt_pk_bf16_f32 v103, v94, v95
    s_waitcnt lgkmcnt(2)
    v_mfma_f32_32x32x16_bf16 v[80:95], v[104:107], v[16:19], v[48:63]
    ds_read_b128 v[104:107], v1 offset:36864
    v_exp_f32 v64, v64
    v_exp_f32 v65, v65
    v_exp_f32 v66, v66
    v_exp_f32 v67, v67
    v_mfma_f32_32x32x16_bf16 v[32:47], v[112:115], v[96:99], v[32:47]
    ds_read_b128 v[112:115], v1 offset:40960
    v_exp_f32 v68, v68
    v_exp_f32 v69, v69
    v_exp_f32 v70, v70
    v_exp_f32 v71, v71
    v_smfmac_f32_16x16x64_bf16 v[28:31], v[24:27], v[96:103], v4
    v_cvt_pk_bf16_f32 v96, v64, v65
    v_cvt_pk_bf16_f32 v97, v66, v67
    v_cvt_pk_bf16_f32 v98, v68, v69
    v_cvt_pk_bf16_f32 v99, v70, v71
    s_waitcnt lgkmcnt(2)
    v_mfma_f32_32x32x16_bf16 v[80:95], v[108:111], v[20:23], v[80:95]
    ds_read_b128 v[108:111], v1 offset:37888
    v_exp_f32 v72, v72
    v_exp_f32 v73, v73
    v_exp_f32 v74, v74
    v_exp_f32 v75, v75
    v_mfma_f32_32x32x16_bf16 v[32:47], v[116:119], v[100:103], v[32:47]
    ds_read_b128 v[116:119], v1 offset:41984
    v_exp_f32 v76, v76
    v_exp_f32 v77, v77
    v_exp_f32 v78, v78
    v_exp_f32 v79, v79
    v_cvt_pk_bf16_f32 v100, v72, v73
    v_cvt_pk_bf16_f32 v101, v74, v75
    v_cvt_pk_bf16_f32 v102, v76, v77
    v_cvt_pk_bf16_f32 v103, v78, v79
    s_waitcnt lgkmcnt(2)
    v_mfma_f32_32x32x16_bf16 v[64:79], v[104:107], v[16:19], v[48:63]
    ds_read_b128 v[104:107], v1 offset:38912
    v_exp_f32 v80, v80
    v_exp_f32 v81, v81
    v_exp_f32 v82, v82
    v_exp_f32 v83, v83
    v_mfma_f32_32x32x16_bf16 v[32:47], v[112:115], v[96:99], v[32:47]
    ds_read_b128 v[112:115], v1 offset:43008
    v_exp_f32 v84, v84
    v_exp_f32 v85, v85
    v_exp_f32 v86, v86
    v_exp_f32 v87, v87
    v_smfmac_f32_16x16x64_bf16 v[28:31], v[24:27], v[96:103], v4
    v_cvt_pk_bf16_f32 v96, v80, v81
    v_cvt_pk_bf16_f32 v97, v82, v83
    v_cvt_pk_bf16_f32 v98, v84, v85
    v_cvt_pk_bf16_f32 v99, v86, v87
    s_waitcnt lgkmcnt(2)
    v_mfma_f32_32x32x16_bf16 v[64:79], v[108:111], v[20:23], v[64:79]
    ds_read_b128 v[108:111], v1 offset:39936
    v_exp_f32 v88, v88
    v_exp_f32 v89, v89
    v_exp_f32 v90, v90
    v_exp_f32 v91, v91
    v_mfma_f32_32x32x16_bf16 v[32:47], v[116:119], v[100:103], v[32:47]
    ds_read_b128 v[116:119], v1 offset:44032
    v_exp_f32 v92, v92
    v_exp_f32 v93, v93
    v_exp_f32 v94, v94
    v_exp_f32 v95, v95
    v_cvt_pk_bf16_f32 v100, v88, v89
    v_cvt_pk_bf16_f32 v101, v90, v91
    v_cvt_pk_bf16_f32 v102, v92, v93
    v_cvt_pk_bf16_f32 v103, v94, v95
    s_waitcnt vmcnt(0) lgkmcnt(2)
    s_barrier
    v_mfma_f32_32x32x16_bf16 v[80:95], v[104:107], v[16:19], v[48:63]
    ds_read_b128 v[104:107], v1 offset:49152
    v_exp_f32 v64, v64
    v_exp_f32 v65, v65
    v_exp_f32 v66, v66
    v_exp_f32 v67, v67
    v_mfma_f32_32x32x16_bf16 v[32:47], v[112:115], v[96:99], v[32:47]
    ds_read_b128 v[112:115], v1 offset:45056
    v_exp_f32 v68, v68
    v_exp_f32 v69, v69
    v_exp_f32 v70, v70
    v_exp_f32 v71, v71
    v_smfmac_f32_16x16x64_bf16 v[28:31], v[24:27], v[96:103], v4
    v_cvt_pk_bf16_f32 v96, v64, v65
    v_cvt_pk_bf16_f32 v97, v66, v67
    v_cvt_pk_bf16_f32 v98, v68, v69
    v_cvt_pk_bf16_f32 v99, v70, v71
    s_waitcnt lgkmcnt(2)
    v_mfma_f32_32x32x16_bf16 v[80:95], v[108:111], v[20:23], v[80:95]
    ds_read_b128 v[108:111], v1 offset:50176
    v_exp_f32 v72, v72
    v_exp_f32 v73, v73
    v_exp_f32 v74, v74
    v_exp_f32 v75, v75
    v_mfma_f32_32x32x16_bf16 v[32:47], v[116:119], v[100:103], v[32:47]
    ds_read_b128 v[116:119], v1 offset:46080
    v_exp_f32 v76, v76
    v_exp_f32 v77, v77
    v_exp_f32 v78, v78
    v_exp_f32 v79, v79
    v_cvt_pk_bf16_f32 v100, v72, v73
    v_cvt_pk_bf16_f32 v101, v74, v75
    v_cvt_pk_bf16_f32 v102, v76, v77
    v_cvt_pk_bf16_f32 v103, v78, v79
    s_waitcnt lgkmcnt(2)
    v_mfma_f32_32x32x16_bf16 v[64:79], v[104:107], v[16:19], v[48:63]
    ds_read_b128 v[104:107], v1 offset:51200
    v_exp_f32 v80, v80
    v_exp_f32 v81, v81
    v_exp_f32 v82, v82
    v_exp_f32 v83, v83
    v_mfma_f32_32x32x16_bf16 v[32:47], v[112:115], v[96:99], v[32:47]
    ds_read_b128 v[112:115], v1 offset:47104
    v_exp_f32 v84, v84
    v_exp_f32 v85, v85
    v_exp_f32 v86, v86
    v_exp_f32 v87, v87
    v_smfmac_f32_16x16x64_bf16 v[28:31], v[24:27], v[96:103], v4
    v_cvt_pk_bf16_f32 v96, v80, v81
    v_cvt_pk_bf16_f32 v97, v82, v83
    v_cvt_pk_bf16_f32 v98, v84, v85
    v_cvt_pk_bf16_f32 v99, v86, v87
    s_waitcnt lgkmcnt(2)
    v_mfma_f32_32x32x16_bf16 v[64:79], v[108:111], v[20:23], v[64:79]
    ds_read_b128 v[108:111], v1 offset:52224
    v_exp_f32 v88, v88
    v_exp_f32 v89, v89
    v_exp_f32 v90, v90
    v_exp_f32 v91, v91
    v_mfma_f32_32x32x16_bf16 v[32:47], v[116:119], v[100:103], v[32:47]
    ds_read_b128 v[116:119], v1 offset:48128
    v_exp_f32 v92, v92
    v_exp_f32 v93, v93
    v_exp_f32 v94, v94
    v_exp_f32 v95, v95
    v_cvt_pk_bf16_f32 v100, v88, v89
    v_cvt_pk_bf16_f32 v101, v90, v91
    v_cvt_pk_bf16_f32 v102, v92, v93
    v_cvt_pk_bf16_f32 v103, v94, v95
    s_waitcnt lgkmcnt(2)
    v_mfma_f32_32x32x16_bf16 v[80:95], v[104:107], v[16:19], v[48:63]
    ds_read_b128 v[104:107], v1 offset:53248
    v_exp_f32 v64, v64
    v_exp_f32 v65, v65
    v_exp_f32 v66, v66
    v_exp_f32 v67, v67
    v_mfma_f32_32x32x16_bf16 v[32:47], v[112:115], v[96:99], v[32:47]
    ds_read_b128 v[112:115], v1 offset:57344
    v_exp_f32 v68, v68
    v_exp_f32 v69, v69
    v_exp_f32 v70, v70
    v_exp_f32 v71, v71
    v_smfmac_f32_16x16x64_bf16 v[28:31], v[24:27], v[96:103], v4
    v_cvt_pk_bf16_f32 v96, v64, v65
    v_cvt_pk_bf16_f32 v97, v66, v67
    v_cvt_pk_bf16_f32 v98, v68, v69
    v_cvt_pk_bf16_f32 v99, v70, v71
    s_waitcnt lgkmcnt(2)
    v_mfma_f32_32x32x16_bf16 v[80:95], v[108:111], v[20:23], v[80:95]
    ds_read_b128 v[108:111], v1 offset:54272
    v_exp_f32 v72, v72
    v_exp_f32 v73, v73
    v_exp_f32 v74, v74
    v_exp_f32 v75, v75
    v_mfma_f32_32x32x16_bf16 v[32:47], v[116:119], v[100:103], v[32:47]
    ds_read_b128 v[116:119], v1 offset:58368
    v_exp_f32 v76, v76
    v_exp_f32 v77, v77
    v_exp_f32 v78, v78
    v_exp_f32 v79, v79
    v_cvt_pk_bf16_f32 v100, v72, v73
    v_cvt_pk_bf16_f32 v101, v74, v75
    v_cvt_pk_bf16_f32 v102, v76, v77
    v_cvt_pk_bf16_f32 v103, v78, v79
    s_waitcnt lgkmcnt(2)
    v_mfma_f32_32x32x16_bf16 v[64:79], v[104:107], v[16:19], v[48:63]
    ds_read_b128 v[104:107], v1 offset:55296
    v_exp_f32 v80, v80
    v_exp_f32 v81, v81
    v_exp_f32 v82, v82
    v_exp_f32 v83, v83
    v_mfma_f32_32x32x16_bf16 v[32:47], v[112:115], v[96:99], v[32:47]
    ds_read_b128 v[112:115], v1 offset:59392
    v_exp_f32 v84, v84
    v_exp_f32 v85, v85
    v_exp_f32 v86, v86
    v_exp_f32 v87, v87
    v_smfmac_f32_16x16x64_bf16 v[28:31], v[24:27], v[96:103], v4
    v_cvt_pk_bf16_f32 v96, v80, v81
    v_cvt_pk_bf16_f32 v97, v82, v83
    v_cvt_pk_bf16_f32 v98, v84, v85
    v_cvt_pk_bf16_f32 v99, v86, v87
    s_waitcnt lgkmcnt(2)
    v_mfma_f32_32x32x16_bf16 v[64:79], v[108:111], v[20:23], v[64:79]
    ds_read_b128 v[108:111], v1 offset:56320
    v_exp_f32 v88, v88
    v_exp_f32 v89, v89
    v_exp_f32 v90, v90
    v_exp_f32 v91, v91
    v_mfma_f32_32x32x16_bf16 v[32:47], v[116:119], v[100:103], v[32:47]
    ds_read_b128 v[116:119], v1 offset:60416
    v_exp_f32 v92, v92
    v_exp_f32 v93, v93
    v_exp_f32 v94, v94
    v_exp_f32 v95, v95
    v_cvt_pk_bf16_f32 v100, v88, v89
    v_cvt_pk_bf16_f32 v101, v90, v91
    v_cvt_pk_bf16_f32 v102, v92, v93
    v_cvt_pk_bf16_f32 v103, v94, v95
    s_waitcnt lgkmcnt(2)
    v_mfma_f32_32x32x16_bf16 v[80:95], v[104:107], v[16:19], v[48:63]
    v_exp_f32 v64, v64
    v_exp_f32 v65, v65
    v_exp_f32 v66, v66
    v_exp_f32 v67, v67
    v_mfma_f32_32x32x16_bf16 v[32:47], v[112:115], v[96:99], v[32:47]
    ds_read_b128 v[112:115], v1 offset:61440
    v_exp_f32 v68, v68
    v_exp_f32 v69, v69
    v_exp_f32 v70, v70
    v_exp_f32 v71, v71
    v_smfmac_f32_16x16x64_bf16 v[28:31], v[24:27], v[96:103], v4
    v_cvt_pk_bf16_f32 v96, v64, v65
    v_cvt_pk_bf16_f32 v97, v66, v67
    v_cvt_pk_bf16_f32 v98, v68, v69
    v_cvt_pk_bf16_f32 v99, v70, v71
    s_waitcnt lgkmcnt(1)
    v_mfma_f32_32x32x16_bf16 v[80:95], v[108:111], v[20:23], v[80:95]
    v_exp_f32 v72, v72
    v_exp_f32 v73, v73
    v_exp_f32 v74, v74
    v_exp_f32 v75, v75
    v_mfma_f32_32x32x16_bf16 v[32:47], v[116:119], v[100:103], v[32:47]
    ds_read_b128 v[116:119], v1 offset:62464
    v_exp_f32 v76, v76
    v_exp_f32 v77, v77
    v_exp_f32 v78, v78
    v_exp_f32 v79, v79
    v_cvt_pk_bf16_f32 v100, v72, v73
    v_cvt_pk_bf16_f32 v101, v74, v75
    v_cvt_pk_bf16_f32 v102, v76, v77
    v_cvt_pk_bf16_f32 v103, v78, v79
    s_waitcnt lgkmcnt(1)
    v_exp_f32 v80, v80
    v_exp_f32 v81, v81
    v_exp_f32 v82, v82
    v_exp_f32 v83, v83
    v_mfma_f32_32x32x16_bf16 v[32:47], v[112:115], v[96:99], v[32:47]
    ds_read_b128 v[112:115], v1 offset:63488
    v_exp_f32 v84, v84
    v_exp_f32 v85, v85
    v_exp_f32 v86, v86
    v_exp_f32 v87, v87
    v_smfmac_f32_16x16x64_bf16 v[28:31], v[24:27], v[96:103], v4
    v_cvt_pk_bf16_f32 v96, v80, v81
    v_cvt_pk_bf16_f32 v97, v82, v83
    v_cvt_pk_bf16_f32 v98, v84, v85
    v_cvt_pk_bf16_f32 v99, v86, v87
    s_waitcnt lgkmcnt(1)
    v_exp_f32 v88, v88
    v_exp_f32 v89, v89
    v_exp_f32 v90, v90
    v_exp_f32 v91, v91
    v_mfma_f32_32x32x16_bf16 v[32:47], v[116:119], v[100:103], v[32:47]
    ds_read_b128 v[116:119], v1 offset:64512
    v_exp_f32 v92, v92
    v_exp_f32 v93, v93
    v_exp_f32 v94, v94
    v_exp_f32 v95, v95
    v_cvt_pk_bf16_f32 v100, v88, v89
    v_cvt_pk_bf16_f32 v101, v90, v91
    v_cvt_pk_bf16_f32 v102, v92, v93
    v_cvt_pk_bf16_f32 v103, v94, v95
    s_waitcnt lgkmcnt(0)
    s_nop 0
    v_smfmac_f32_16x16x64_bf16 v[28:31], v[24:27], v[96:103], v4
    v_mfma_f32_32x32x16_bf16 v[32:47], v[112:115], v[96:99], v[32:47]
    v_mfma_f32_32x32x16_bf16 v[32:47], v[116:119], v[100:103], v[32:47]
    s_nop 9
    v_add_f32 v28, v28, v29
    v_mov_b32 v8, 0x207
    v_mov_b32 v9, 0x5f800000
    v_cmp_nlt_f32 s[22:23], v28, v9
    v_cmp_class_f32 vcc, v32, v8
    s_nop 0
    s_or_b64 s[22:23], s[22:23], vcc
    v_cmp_class_f32 vcc, v33, v8
    s_nop 0
    s_or_b64 s[22:23], s[22:23], vcc
    v_cmp_class_f32 vcc, v34, v8
    s_nop 0
    s_or_b64 s[22:23], s[22:23], vcc
    v_cmp_class_f32 vcc, v35, v8
    s_nop 0
    s_or_b64 s[22:23], s[22:23], vcc
    v_cmp_class_f32 vcc, v36, v8
    s_nop 0
    s_or_b64 s[22:23], s[22:23], vcc
    v_cmp_class_f32 vcc, v37, v8
    s_nop 0
    s_or_b64 s[22:23], s[22:23], vcc
    v_cmp_class_f32 vcc, v38, v8
    s_nop 0
    s_or_b64 s[22:23], s[22:23], vcc
    v_cmp_class_f32 vcc, v39, v8
    s_nop 0
    s_or_b64 s[22:23], s[22:23], vcc
    v_cmp_class_f32 vcc, v40, v8
    s_nop 0
    s_or_b64 s[22:23], s[22:23], vcc
    v_cmp_class_f32 vcc, v41, v8
    s_nop 0
    s_or_b64 s[22:23], s[22:23], vcc
    v_cmp_class_f32 vcc, v42, v8
    s_nop 0
    s_or_b64 s[22:23], s[22:23], vcc
    v_cmp_class_f32 vcc, v43, v8
    s_nop 0
    s_or_b64 s[22:23], s[22:23], vcc
    v_cmp_class_f32 vcc, v44, v8
    s_nop 0
    s_or_b64 s[22:23], s[22:23], vcc
    v_cmp_class_f32 vcc, v45, v8
    s_nop 0
    s_or_b64 s[22:23], s[22:23], vcc
    v_cmp_class_f32 vcc, v46, v8
    s_nop 0
    s_or_b64 s[22:23], s[22:23], vcc
    v_cmp_class_f32 vcc, v47, v8
    s_nop 0
    s_or_b64 s[22:23], s[22:23], vcc
    s_cmp_lg_u64 s[22:23], 0
    s_cbranch_scc1 k2_kernel_slow
k2_kernel_fin:
    v_rcp_f32 v8, v28
    s_mul_i32 s16, s10, 294912
    s_lshl_b32 s17, s9, 11
    s_add_u32 s16, s16, s17
    s_add_u32 s16, s16, 0x1000000
    v_mul_f32 v8, v8, v2
    v_mul_f32 v32, v32, v8
    v_mul_f32 v33, v33, v8
    v_mul_f32 v34, v34, v8
    v_mul_f32 v35, v35, v8
    v_mul_f32 v36, v36, v8
    v_mul_f32 v37, v37, v8
    v_mul_f32 v38, v38, v8
    v_mul_f32 v39, v39, v8
    v_mul_f32 v40, v40, v8
    v_mul_f32 v41, v41, v8
    v_mul_f32 v42, v42, v8
    v_mul_f32 v43, v43, v8
    v_mul_f32 v44, v44, v8
    v_mul_f32 v45, v45, v8
    v_mul_f32 v46, v46, v8
    v_mul_f32 v47, v47, v8
    v_cvt_pk_bf16_f32 v64, v32, v33
    v_cvt_pk_bf16_f32 v65, v34, v35
    v_cvt_pk_bf16_f32 v66, v36, v37
    v_cvt_pk_bf16_f32 v67, v38, v39
    v_cvt_pk_bf16_f32 v68, v40, v41
    v_cvt_pk_bf16_f32 v69, v42, v43
    v_cvt_pk_bf16_f32 v70, v44, v45
    v_cvt_pk_bf16_f32 v71, v46, v47
    v_permlane32_swap_b32 v64, v66
    v_permlane32_swap_b32 v65, v67
    buffer_store_dwordx4 v[64:67], v1, s[4:7], s16 offen offset:0 sc1
    v_permlane32_swap_b32 v68, v70
    v_permlane32_swap_b32 v69, v71
    buffer_store_dwordx4 v[68:71], v1, s[4:7], s16 offen offset:1024 sc1
    s_lshr_b32 s16, s10, 3
    s_lshl_b32 s16, s16, 12
    s_lshr_b32 s17, s9, 4
    s_lshl_b32 s17, s17, 7
    s_add_u32 s16, s16, s17
    s_and_b32 s17, s9, 15
    s_lshl_b32 s17, s17, 2
    s_add_u32 s16, s16, s17
    s_add_u32 s16, s16, 0x2300000
    v_lshlrev_b32 v8, 8, v0
    v_mov_b32 v9, 1
    s_waitcnt vmcnt(0)
    s_barrier
    s_cmp_lg_u32 s8, 0
    s_cbranch_scc1 k2_kernel_sig
    s_mov_b64 exec, 0xffff
    buffer_store_dword v9, v8, s[4:7], s16 offen sc1
    s_mov_b64 exec, -1
k2_kernel_sig:
    s_endpgm
k2_kernel_slow:
    s_lshl_b32 s11, s9, 17
    s_add_u32 s12, s11, 8388608
    s_add_u32 s11, s11, 4194304
    v_mov_b32 v8, 0xff800000
    s_mov_b32 s14, 64
    v_mov_b32 v28, 0
    v_mov_b32 v29, 0
    v_mov_b32 v30, 0
    v_mov_b32 v31, 0
    v_mov_b32 v32, 0
    v_mov_b32 v33, 0
    v_mov_b32 v34, 0
    v_mov_b32 v35, 0
    v_mov_b32 v36, 0
    v_mov_b32 v37, 0
    v_mov_b32 v38, 0
    v_mov_b32 v39, 0
    v_mov_b32 v40, 0
    v_mov_b32 v41, 0
    v_mov_b32 v42, 0
    v_mov_b32 v43, 0
    v_mov_b32 v44, 0
    v_mov_b32 v45, 0
    v_mov_b32 v46, 0
    v_mov_b32 v47, 0
k2_kernel_sloop:
    s_add_u32 s16, s11, 65536
    buffer_load_dwordx4 v[104:107], v1, s[4:7], s11 offen
    buffer_load_dwordx4 v[108:111], v1, s[4:7], s16 offen
    buffer_load_dwordx4 v[112:115], v1, s[4:7], s12 offen
    buffer_load_dwordx4 v[116:119], v1, s[4:7], s12 offen offset:1024
    s_add_u32 s11, s11, 1024
    s_add_u32 s12, s12, 2048
    s_waitcnt vmcnt(0)
    v_mfma_f32_32x32x16_bf16 v[64:79], v[104:107], v[16:19], 0
    v_mfma_f32_32x32x16_bf16 v[64:79], v[108:111], v[20:23], v[64:79]
    s_nop 11
    v_max3_f32 v9, v64, v65, v66
    v_max3_f32 v10, v67, v68, v69
    v_max3_f32 v9, v9, v70, v71
    v_max3_f32 v10, v10, v72, v73
    v_max3_f32 v9, v9, v74, v75
    v_max3_f32 v10, v10, v76, v77
    v_max3_f32 v9, v9, v78, v79
    v_max_f32 v9, v9, v10
    v_mov_b32 v10, v9
    s_nop 1
    v_permlane32_swap_b32 v9, v10
    v_max_f32 v9, v9, v10
    v_max_f32 v10, v9, v8
    v_sub_f32 v9, v8, v10
    v_exp_f32 v9, v9
    v_mov_b32 v8, v10
    v_sub_f32 v64, v64, v8
    v_sub_f32 v65, v65, v8
    v_sub_f32 v66, v66, v8
    v_sub_f32 v67, v67, v8
    v_sub_f32 v68, v68, v8
    v_sub_f32 v69, v69, v8
    v_sub_f32 v70, v70, v8
    v_sub_f32 v71, v71, v8
    v_sub_f32 v72, v72, v8
    v_sub_f32 v73, v73, v8
    v_sub_f32 v74, v74, v8
    v_sub_f32 v75, v75, v8
    v_sub_f32 v76, v76, v8
    v_sub_f32 v77, v77, v8
    v_sub_f32 v78, v78, v8
    v_sub_f32 v79, v79, v8
    v_exp_f32 v64, v64
    v_exp_f32 v65, v65
    v_exp_f32 v66, v66
    v_exp_f32 v67, v67
    v_exp_f32 v68, v68
    v_exp_f32 v69, v69
    v_exp_f32 v70, v70
    v_exp_f32 v71, v71
    v_exp_f32 v72, v72
    v_exp_f32 v73, v73
    v_exp_f32 v74, v74
    v_exp_f32 v75, v75
    v_exp_f32 v76, v76
    v_exp_f32 v77, v77
    v_exp_f32 v78, v78
    v_exp_f32 v79, v79
    v_mul_f32 v28, v28, v9
    v_mul_f32 v29, v29, v9
    v_mul_f32 v30, v30, v9
    v_mul_f32 v31, v31, v9
    v_mul_f32 v32, v32, v9
    v_mul_f32 v33, v33, v9
    v_mul_f32 v34, v34, v9
    v_mul_f32 v35, v35, v9
    v_mul_f32 v36, v36, v9
    v_mul_f32 v37, v37, v9
    v_mul_f32 v38, v38, v9
    v_mul_f32 v39, v39, v9
    v_mul_f32 v40, v40, v9
    v_mul_f32 v41, v41, v9
    v_mul_f32 v42, v42, v9
    v_mul_f32 v43, v43, v9
    v_mul_f32 v44, v44, v9
    v_mul_f32 v45, v45, v9
    v_mul_f32 v46, v46, v9
    v_mul_f32 v47, v47, v9
    v_cvt_pk_bf16_f32 v96, v64, v65
    v_cvt_pk_bf16_f32 v97, v66, v67
    v_cvt_pk_bf16_f32 v98, v68, v69
    v_cvt_pk_bf16_f32 v99, v70, v71
    v_cvt_pk_bf16_f32 v100, v72, v73
    v_cvt_pk_bf16_f32 v101, v74, v75
    v_cvt_pk_bf16_f32 v102, v76, v77
    v_cvt_pk_bf16_f32 v103, v78, v79
    s_nop 1
    v_smfmac_f32_16x16x64_bf16 v[28:31], v[24:27], v[96:103], v4
    v_mfma_f32_32x32x16_bf16 v[32:47], v[112:115], v[96:99], v[32:47]
    v_mfma_f32_32x32x16_bf16 v[32:47], v[116:119], v[100:103], v[32:47]
    s_nop 15
    s_sub_u32 s14, s14, 1
    s_cmp_lg_u32 s14, 0
    s_cbranch_scc1 k2_kernel_sloop
    v_add_f32 v28, v28, v29
    s_branch k2_kernel_fin
k2_kernel_down:
    s_load_dwordx2 s[40:41], s[0:1], 16
    s_load_dwordx2 s[42:43], s[0:1], 48
    s_load_dwordx2 s[44:45], s[0:1], 64
    s_load_dwordx2 s[46:47], s[0:1], 80
    v_lshrrev_b32 v17, 6, v0
    v_and_b32 v0, 63, v0
    v_readfirstlane_b32 s16, v17
    s_and_b32 s30, s2, 7
    s_lshr_b32 s31, s2, 3
    s_and_b32 s31, s31, 31
    s_and_b32 s21, s30, 1
    s_lshr_b32 s30, s30, 1
    s_lshl_b32 s19, s30, 2
    s_lshr_b32 s32, s31, 3
    s_add_u32 s19, s19, s32
    s_and_b32 s20, s31, 7
    s_lshr_b32 s17, s16, 2
    s_and_b32 s18, s16, 3
    v_lshlrev_b32 v1, 4, v0
    s_lshl_b32 s30, s19, 2
    s_lshr_b32 s31, s16, 1
    s_add_u32 s30, s30, s31
    s_mul_i32 s39, s30, 294912
    s_add_u32 s39, s39, 0x1000000
    s_and_b32 s30, s16, 1
    s_lshl_b32 s30, s30, 10
    s_add_u32 s39, s39, s30
    s_mul_i32 s30, s21, 114688
    s_add_u32 s22, s39, s30
    s_add_u32 s22, s22, 65536
    s_mul_i32 s23, s21, 3670016
    s_lshl_b32 s24, s16, 10
    s_add_u32 s25, s24, 8192
    v_lshrrev_b32 v17, 2, v0
    s_lshl_b32 s30, s17, 4
    v_add_u32 v17, s30, v17
    v_lshlrev_b32 v17, 11, v17
    v_lshrrev_b32 v18, 5, v0
    v_lshlrev_b32 v18, 1, v18
    v_and_b32 v19, 3, v0
    v_xor_b32 v18, v18, v19
    v_lshlrev_b32 v18, 4, v18
    s_lshl_b32 s30, s20, 8
    s_lshl_b32 s31, s18, 6
    s_add_u32 s30, s30, s31
    v_add3_u32 v2, v17, v18, s30
    s_mov_b32 s26, 0
    s_waitcnt lgkmcnt(0)
    s_mov_b32 s4, s46
    s_mov_b32 s5, s47
    s_mov_b32 s6, 0x10000000
    s_mov_b32 s7, 0x20000
    s_mov_b32 s8, s42
    s_mov_b32 s9, s43
    s_mov_b32 s10, 7340032
    s_mov_b32 s11, 0x20000
    s_add_u32 m0, s24, 0
    s_nop 0
    buffer_load_dwordx4 v1, s[4:7], s22 offen sc1 lds
    s_add_u32 s22, s22, 2048
    s_add_u32 m0, s24, 40960
    s_nop 0
    buffer_load_dwordx4 v2, s[8:11], s23 offen lds
    s_add_u32 s23, s23, 65536
    s_add_u32 m0, s24, 8192
    s_nop 0
    buffer_load_dwordx4 v1, s[4:7], s22 offen sc1 lds
    s_add_u32 s22, s22, 2048
    s_add_u32 m0, s24, 49152
    s_nop 0
    buffer_load_dwordx4 v2, s[8:11], s23 offen lds
    s_add_u32 s23, s23, 65536
    s_mov_b32 s12, s46
    s_mov_b32 s13, s47
    s_mov_b32 s14, 0x10000000
    s_mov_b32 s15, 0x20000
    s_mov_b32 s48, s44
    s_mov_b32 s49, s45
    s_mov_b32 s50, 4194304
    s_mov_b32 s51, 0x20000
    v_and_b32 v17, 15, v0
    v_lshrrev_b32 v18, 4, v0
    v_lshlrev_b32 v19, 9, v18
    v_lshl_add_u32 v19, v17, 4, v19
    s_lshl_b32 s30, s17, 12
    s_lshl_b32 s31, s21, 11
    s_add_u32 s30, s30, s31
    v_add_u32 v3, s30, v19
    v_xor_b32 v4, 2048, v3
    v_lshrrev_b32 v19, 5, v0
    v_lshlrev_b32 v19, 12, v19
    v_and_b32 v18, 1, v18
    v_lshl_add_u32 v19, v18, 9, v19
    v_lshl_add_u32 v19, v18, 5, v19
    v_lshrrev_b32 v18, 2, v17
    v_lshl_add_u32 v19, v18, 6, v19
    v_and_b32 v18, 3, v17
    v_lshl_add_u32 v19, v18, 3, v19
    s_lshl_b32 s30, s18, 10
    s_add_u32 s30, s30, 40960
    v_add_u32 v5, s30, v19
    v_xor_b32 v6, 32, v5
    s_mov_b32 s27, 7
    v_lshlrev_b32 v12, 2, v17
    s_lshl_b32 s37, s19, 3
    s_add_u32 s37, s37, s20
    s_lshl_b32 s37, s37, 1
    s_add_u32 s37, s37, s21
    s_lshl_b32 s37, s37, 7
    s_add_u32 s37, s37, 0x2300000
    s_lshl_b32 s38, s2, 3
    s_add_u32 s38, s38, s16
    s_lshl_b32 s38, s38, 6
    s_add_u32 s38, s38, 0x2300000
    s_lshl_b32 s36, s19, 2
    s_lshl_b32 s30, s17, 1
    s_add_u32 s36, s36, s30
    s_add_u32 s36, s36, s21
    s_lshl_b32 s34, s36, 7
    s_add_u32 s34, s34, 0x2200000
    s_xor_b32 s35, s34, 128
    v_lshlrev_b32 v17, 2, v17
    v_mov_b32 v20, 0
    v_mov_b32 v21, 0
    v_mov_b32 v22, 0
    v_mov_b32 v23, 0
    v_mov_b32 v24, 0
    v_mov_b32 v25, 0
    v_mov_b32 v26, 0
    v_mov_b32 v27, 0
    v_mov_b32 v28, 0
    v_mov_b32 v29, 0
    v_mov_b32 v30, 0
    v_mov_b32 v31, 0
    v_mov_b32 v32, 0
    v_mov_b32 v33, 0
    v_mov_b32 v34, 0
    v_mov_b32 v35, 0
    v_mov_b32 v36, 0
    v_mov_b32 v37, 0
    v_mov_b32 v38, 0
    v_mov_b32 v39, 0
    v_mov_b32 v40, 0
    v_mov_b32 v41, 0
    v_mov_b32 v42, 0
    v_mov_b32 v43, 0
    v_mov_b32 v44, 0
    v_mov_b32 v45, 0
    v_mov_b32 v46, 0
    v_mov_b32 v47, 0
    v_mov_b32 v48, 0
    v_mov_b32 v49, 0
    v_mov_b32 v50, 0
    v_mov_b32 v51, 0
    s_waitcnt vmcnt(2)
    s_barrier
    ds_read_b64_tr_b16 v[68:69], v5 offset:0
    ds_read_b64_tr_b16 v[70:71], v5 offset:256
    ds_read_b128 v[52:55], v3 offset:0
    ds_read_b128 v[56:59], v3 offset:256
    ds_read_b128 v[60:63], v4 offset:0
    ds_read_b128 v[64:67], v4 offset:256
    ds_read_b64_tr_b16 v[72:73], v6 offset:0
    ds_read_b64_tr_b16 v[74:75], v6 offset:256
    s_add_u32 m0, s24, 16384
    s_nop 0
    buffer_load_dwordx4 v1, s[4:7], s22 offen sc1 lds
    s_add_u32 s22, s22, 2048
    s_add_u32 m0, s24, 57344
    s_nop 0
    buffer_load_dwordx4 v2, s[8:11], s23 offen lds
    s_add_u32 s23, s23, 65536
    s_waitcnt vmcnt(2) lgkmcnt(0)
    s_barrier
    v_mfma_f32_16x16x32_bf16 v[20:23], v[68:71], v[52:55], v[20:23]
    ds_read_b64_tr_b16 v[92:93], v5 offset:8192
    ds_read_b64_tr_b16 v[94:95], v5 offset:8448
    v_mfma_f32_16x16x32_bf16 v[28:31], v[68:71], v[56:59], v[28:31]
    ds_read_b128 v[76:79], v3 offset:8192
    ds_read_b128 v[80:83], v3 offset:8448
    v_mfma_f32_16x16x32_bf16 v[36:39], v[68:71], v[60:63], v[36:39]
    ds_read_b128 v[84:87], v4 offset:8192
    ds_read_b128 v[88:91], v4 offset:8448
    v_mfma_f32_16x16x32_bf16 v[44:47], v[68:71], v[64:67], v[44:47]
    ds_read_b64_tr_b16 v[96:97], v6 offset:8192
    ds_read_b64_tr_b16 v[98:99], v6 offset:8448
    s_add_u32 m0, s24, 24576
    v_mfma_f32_16x16x32_bf16 v[24:27], v[72:75], v[52:55], v[24:27]
    buffer_load_dwordx4 v1, s[4:7], s22 offen sc1 lds
    s_add_u32 s22, s22, 2048
    s_add_u32 m0, s24, 65536
    s_nop 0
    buffer_load_dwordx4 v2, s[8:11], s23 offen lds
    s_add_u32 s23, s23, 65536
    s_add_u32 m0, s24, 32768
    v_mfma_f32_16x16x32_bf16 v[32:35], v[72:75], v[56:59], v[32:35]
    buffer_load_dwordx4 v1, s[4:7], s22 offen sc1 lds
    s_add_u32 s22, s22, 2048
    s_add_u32 m0, s24, 73728
    s_nop 0
    buffer_load_dwordx4 v2, s[8:11], s23 offen lds
    s_add_u32 s23, s23, 65536
    v_mfma_f32_16x16x32_bf16 v[40:43], v[72:75], v[60:63], v[40:43]
    v_mfma_f32_16x16x32_bf16 v[48:51], v[72:75], v[64:67], v[48:51]
    s_waitcnt vmcnt(4) lgkmcnt(0)
    s_barrier
    v_mfma_f32_16x16x32_bf16 v[20:23], v[92:95], v[76:79], v[20:23]
    ds_read_b64_tr_b16 v[68:69], v5 offset:16384
    ds_read_b64_tr_b16 v[70:71], v5 offset:16640
    v_mfma_f32_16x16x32_bf16 v[28:31], v[92:95], v[80:83], v[28:31]
    ds_read_b128 v[52:55], v3 offset:16384
    ds_read_b128 v[56:59], v3 offset:16640
    v_mfma_f32_16x16x32_bf16 v[36:39], v[92:95], v[84:87], v[36:39]
    ds_read_b128 v[60:63], v4 offset:16384
    ds_read_b128 v[64:67], v4 offset:16640
    v_mfma_f32_16x16x32_bf16 v[44:47], v[92:95], v[88:91], v[44:47]
    ds_read_b64_tr_b16 v[72:73], v6 offset:16384
    ds_read_b64_tr_b16 v[74:75], v6 offset:16640
    s_add_u32 m0, s24, 0
    v_mfma_f32_16x16x32_bf16 v[24:27], v[96:99], v[76:79], v[24:27]
    buffer_load_dwordx4 v1, s[4:7], s22 offen sc1 lds
    s_add_u32 s22, s22, 2048
    s_add_u32 m0, s24, 40960
    s_nop 0
    buffer_load_dwordx4 v2, s[8:11], s23 offen lds
    s_add_u32 s23, s23, 65536
    s_add_u32 m0, s24, 8192
    s_nop 0
    buffer_load_dwordx4 v1, s[4:7], s22 offen sc1 lds
    s_add_u32 s22, s22, 2048
    s_add_u32 m0, s24, 49152
    s_nop 0
    buffer_load_dwordx4 v2, s[8:11], s23 offen lds
    s_add_u32 s23, s23, 65536
    v_mfma_f32_16x16x32_bf16 v[32:35], v[96:99], v[80:83], v[32:35]
    buffer_load_dword v13, v17, s[12:15], s34 offen offset:0
    buffer_load_dword v14, v17, s[12:15], s34 offen offset:64
    buffer_load_dword v15, v17, s[12:15], s35 offen offset:0
    buffer_load_dword v16, v17, s[12:15], s35 offen offset:64
    v_mfma_f32_16x16x32_bf16 v[40:43], v[96:99], v[84:87], v[40:43]
    v_mfma_f32_16x16x32_bf16 v[48:51], v[96:99], v[88:91], v[48:51]
k2_kernel_d_loop:
    s_waitcnt vmcnt(6) lgkmcnt(0)
    s_barrier
    v_mfma_f32_16x16x32_bf16 v[20:23], v[68:71], v[52:55], v[20:23]
    ds_read_b64_tr_b16 v[92:93], v5 offset:24576
    ds_read_b64_tr_b16 v[94:95], v5 offset:24832
    v_mfma_f32_16x16x32_bf16 v[28:31], v[68:71], v[56:59], v[28:31]
    ds_read_b128 v[76:79], v3 offset:24576
    ds_read_b128 v[80:83], v3 offset:24832
    v_mfma_f32_16x16x32_bf16 v[36:39], v[68:71], v[60:63], v[36:39]
    ds_read_b128 v[84:87], v4 offset:24576
    ds_read_b128 v[88:91], v4 offset:24832
    v_mfma_f32_16x16x32_bf16 v[44:47], v[68:71], v[64:67], v[44:47]
    ds_read_b64_tr_b16 v[96:97], v6 offset:24576
    ds_read_b64_tr_b16 v[98:99], v6 offset:24832
    s_add_u32 m0, s24, 16384
    v_mfma_f32_16x16x32_bf16 v[24:27], v[72:75], v[52:55], v[24:27]
    buffer_load_dwordx4 v1, s[4:7], s22 offen sc1 lds
    s_add_u32 s22, s22, 2048
    s_add_u32 m0, s24, 57344
    v_mfma_f32_16x16x32_bf16 v[32:35], v[72:75], v[56:59], v[32:35]
    buffer_load_dwordx4 v2, s[8:11], s23 offen lds
    s_add_u32 s23, s23, 65536
    v_mfma_f32_16x16x32_bf16 v[40:43], v[72:75], v[60:63], v[40:43]
    v_mfma_f32_16x16x32_bf16 v[48:51], v[72:75], v[64:67], v[48:51]
    s_waitcnt vmcnt(6) lgkmcnt(0)
    s_barrier
    v_mfma_f32_16x16x32_bf16 v[20:23], v[92:95], v[76:79], v[20:23]
    ds_read_b64_tr_b16 v[68:69], v5 offset:32768
    ds_read_b64_tr_b16 v[70:71], v5 offset:33024
    v_mfma_f32_16x16x32_bf16 v[28:31], v[92:95], v[80:83], v[28:31]
    ds_read_b128 v[52:55], v3 offset:32768
    ds_read_b128 v[56:59], v3 offset:33024
    v_mfma_f32_16x16x32_bf16 v[36:39], v[92:95], v[84:87], v[36:39]
    ds_read_b128 v[60:63], v4 offset:32768
    ds_read_b128 v[64:67], v4 offset:33024
    v_mfma_f32_16x16x32_bf16 v[44:47], v[92:95], v[88:91], v[44:47]
    ds_read_b64_tr_b16 v[72:73], v6 offset:32768
    ds_read_b64_tr_b16 v[74:75], v6 offset:33024
    s_add_u32 m0, s24, 24576
    v_mfma_f32_16x16x32_bf16 v[24:27], v[96:99], v[76:79], v[24:27]
    buffer_load_dwordx4 v1, s[4:7], s22 offen sc1 lds
    s_add_u32 s22, s22, 2048
    s_add_u32 m0, s24, 65536
    v_mfma_f32_16x16x32_bf16 v[32:35], v[96:99], v[80:83], v[32:35]
    buffer_load_dwordx4 v2, s[8:11], s23 offen lds
    s_add_u32 s23, s23, 65536
    v_mfma_f32_16x16x32_bf16 v[40:43], v[96:99], v[84:87], v[40:43]
    v_mfma_f32_16x16x32_bf16 v[48:51], v[96:99], v[88:91], v[48:51]
    s_waitcnt vmcnt(6) lgkmcnt(0)
    s_barrier
    v_mfma_f32_16x16x32_bf16 v[20:23], v[68:71], v[52:55], v[20:23]
    ds_read_b64_tr_b16 v[92:93], v5 offset:0
    ds_read_b64_tr_b16 v[94:95], v5 offset:256
    v_mfma_f32_16x16x32_bf16 v[28:31], v[68:71], v[56:59], v[28:31]
    ds_read_b128 v[76:79], v3 offset:0
    ds_read_b128 v[80:83], v3 offset:256
    v_mfma_f32_16x16x32_bf16 v[36:39], v[68:71], v[60:63], v[36:39]
    ds_read_b128 v[84:87], v4 offset:0
    ds_read_b128 v[88:91], v4 offset:256
    v_mfma_f32_16x16x32_bf16 v[44:47], v[68:71], v[64:67], v[44:47]
    ds_read_b64_tr_b16 v[96:97], v6 offset:0
    ds_read_b64_tr_b16 v[98:99], v6 offset:256
    s_add_u32 m0, s24, 32768
    v_mfma_f32_16x16x32_bf16 v[24:27], v[72:75], v[52:55], v[24:27]
    buffer_load_dwordx4 v1, s[4:7], s22 offen sc1 lds
    s_add_u32 s22, s22, 2048
    s_add_u32 m0, s24, 73728
    v_mfma_f32_16x16x32_bf16 v[32:35], v[72:75], v[56:59], v[32:35]
    buffer_load_dwordx4 v2, s[8:11], s23 offen lds
    s_add_u32 s23, s23, 65536
    v_mfma_f32_16x16x32_bf16 v[40:43], v[72:75], v[60:63], v[40:43]
    v_mfma_f32_16x16x32_bf16 v[48:51], v[72:75], v[64:67], v[48:51]
    s_waitcnt vmcnt(6) lgkmcnt(0)
    s_barrier
    v_mfma_f32_16x16x32_bf16 v[20:23], v[92:95], v[76:79], v[20:23]
    ds_read_b64_tr_b16 v[68:69], v5 offset:8192
    ds_read_b64_tr_b16 v[70:71], v5 offset:8448
    v_mfma_f32_16x16x32_bf16 v[28:31], v[92:95], v[80:83], v[28:31]
    ds_read_b128 v[52:55], v3 offset:8192
    ds_read_b128 v[56:59], v3 offset:8448
    v_mfma_f32_16x16x32_bf16 v[36:39], v[92:95], v[84:87], v[36:39]
    ds_read_b128 v[60:63], v4 offset:8192
    ds_read_b128 v[64:67], v4 offset:8448
    v_mfma_f32_16x16x32_bf16 v[44:47], v[92:95], v[88:91], v[44:47]
    ds_read_b64_tr_b16 v[72:73], v6 offset:8192
    ds_read_b64_tr_b16 v[74:75], v6 offset:8448
    s_add_u32 m0, s24, 0
    v_mfma_f32_16x16x32_bf16 v[24:27], v[96:99], v[76:79], v[24:27]
    buffer_load_dwordx4 v1, s[4:7], s22 offen sc1 lds
    s_add_u32 s22, s22, 2048
    s_add_u32 m0, s24, 40960
    v_mfma_f32_16x16x32_bf16 v[32:35], v[96:99], v[80:83], v[32:35]
    buffer_load_dwordx4 v2, s[8:11], s23 offen lds
    s_add_u32 s23, s23, 65536
    v_mfma_f32_16x16x32_bf16 v[40:43], v[96:99], v[84:87], v[40:43]
    v_mfma_f32_16x16x32_bf16 v[48:51], v[96:99], v[88:91], v[48:51]
    s_cmp_eq_u32 s27, 3
    s_cbranch_scc1 k2_kernel_d_fl
    s_cmp_eq_u32 s27, 2
    s_cbranch_scc1 k2_kernel_d_sc
k2_kernel_d_b2:
    s_waitcnt vmcnt(6) lgkmcnt(0)
    s_barrier
    v_mfma_f32_16x16x32_bf16 v[20:23], v[68:71], v[52:55], v[20:23]
    ds_read_b64_tr_b16 v[92:93], v5 offset:16384
    ds_read_b64_tr_b16 v[94:95], v5 offset:16640
    v_mfma_f32_16x16x32_bf16 v[28:31], v[68:71], v[56:59], v[28:31]
    ds_read_b128 v[76:79], v3 offset:16384
    ds_read_b128 v[80:83], v3 offset:16640
    v_mfma_f32_16x16x32_bf16 v[36:39], v[68:71], v[60:63], v[36:39]
    ds_read_b128 v[84:87], v4 offset:16384
    ds_read_b128 v[88:91], v4 offset:16640
    v_mfma_f32_16x16x32_bf16 v[44:47], v[68:71], v[64:67], v[44:47]
    ds_read_b64_tr_b16 v[96:97], v6 offset:16384
    ds_read_b64_tr_b16 v[98:99], v6 offset:16640
    s_add_u32 m0, s24, 8192
    v_mfma_f32_16x16x32_bf16 v[24:27], v[72:75], v[52:55], v[24:27]
    buffer_load_dwordx4 v1, s[4:7], s22 offen sc1 lds
    s_add_u32 s22, s22, 2048
    s_add_u32 m0, s24, 49152
    v_mfma_f32_16x16x32_bf16 v[32:35], v[72:75], v[56:59], v[32:35]
    buffer_load_dwordx4 v2, s[8:11], s23 offen lds
    s_add_u32 s23, s23, 65536
    v_mfma_f32_16x16x32_bf16 v[40:43], v[72:75], v[60:63], v[40:43]
    v_mfma_f32_16x16x32_bf16 v[48:51], v[72:75], v[64:67], v[48:51]
    s_waitcnt vmcnt(6) lgkmcnt(0)
    s_barrier
    v_mfma_f32_16x16x32_bf16 v[20:23], v[92:95], v[76:79], v[20:23]
    ds_read_b64_tr_b16 v[68:69], v5 offset:24576
    ds_read_b64_tr_b16 v[70:71], v5 offset:24832
    v_mfma_f32_16x16x32_bf16 v[28:31], v[92:95], v[80:83], v[28:31]
    ds_read_b128 v[52:55], v3 offset:24576
    ds_read_b128 v[56:59], v3 offset:24832
    v_mfma_f32_16x16x32_bf16 v[36:39], v[92:95], v[84:87], v[36:39]
    ds_read_b128 v[60:63], v4 offset:24576
    ds_read_b128 v[64:67], v4 offset:24832
    v_mfma_f32_16x16x32_bf16 v[44:47], v[92:95], v[88:91], v[44:47]
    ds_read_b64_tr_b16 v[72:73], v6 offset:24576
    ds_read_b64_tr_b16 v[74:75], v6 offset:24832
    s_add_u32 m0, s24, 16384
    v_mfma_f32_16x16x32_bf16 v[24:27], v[96:99], v[76:79], v[24:27]
    buffer_load_dwordx4 v1, s[4:7], s22 offen sc1 lds
    s_add_u32 s22, s22, 2048
    s_add_u32 m0, s24, 57344
    v_mfma_f32_16x16x32_bf16 v[32:35], v[96:99], v[80:83], v[32:35]
    buffer_load_dwordx4 v2, s[8:11], s23 offen lds
    s_add_u32 s23, s23, 65536
    v_mfma_f32_16x16x32_bf16 v[40:43], v[96:99], v[84:87], v[40:43]
    v_mfma_f32_16x16x32_bf16 v[48:51], v[96:99], v[88:91], v[48:51]
    s_waitcnt vmcnt(6) lgkmcnt(0)
    s_barrier
    v_mfma_f32_16x16x32_bf16 v[20:23], v[68:71], v[52:55], v[20:23]
    ds_read_b64_tr_b16 v[92:93], v5 offset:32768
    ds_read_b64_tr_b16 v[94:95], v5 offset:33024
    v_mfma_f32_16x16x32_bf16 v[28:31], v[68:71], v[56:59], v[28:31]
    ds_read_b128 v[76:79], v3 offset:32768
    ds_read_b128 v[80:83], v3 offset:33024
    v_mfma_f32_16x16x32_bf16 v[36:39], v[68:71], v[60:63], v[36:39]
    ds_read_b128 v[84:87], v4 offset:32768
    ds_read_b128 v[88:91], v4 offset:33024
    v_mfma_f32_16x16x32_bf16 v[44:47], v[68:71], v[64:67], v[44:47]
    ds_read_b64_tr_b16 v[96:97], v6 offset:32768
    ds_read_b64_tr_b16 v[98:99], v6 offset:33024
    s_add_u32 m0, s24, 24576
    v_mfma_f32_16x16x32_bf16 v[24:27], v[72:75], v[52:55], v[24:27]
    buffer_load_dwordx4 v1, s[4:7], s22 offen sc1 lds
    s_add_u32 s22, s22, 2048
    s_add_u32 m0, s24, 65536
    v_mfma_f32_16x16x32_bf16 v[32:35], v[72:75], v[56:59], v[32:35]
    buffer_load_dwordx4 v2, s[8:11], s23 offen lds
    s_add_u32 s23, s23, 65536
    v_mfma_f32_16x16x32_bf16 v[40:43], v[72:75], v[60:63], v[40:43]
    v_mfma_f32_16x16x32_bf16 v[48:51], v[72:75], v[64:67], v[48:51]
    s_waitcnt vmcnt(6) lgkmcnt(0)
    s_barrier
    v_mfma_f32_16x16x32_bf16 v[20:23], v[92:95], v[76:79], v[20:23]
    ds_read_b64_tr_b16 v[68:69], v5 offset:0
    ds_read_b64_tr_b16 v[70:71], v5 offset:256
    v_mfma_f32_16x16x32_bf16 v[28:31], v[92:95], v[80:83], v[28:31]
    ds_read_b128 v[52:55], v3 offset:0
    ds_read_b128 v[56:59], v3 offset:256
    v_mfma_f32_16x16x32_bf16 v[36:39], v[92:95], v[84:87], v[36:39]
    ds_read_b128 v[60:63], v4 offset:0
    ds_read_b128 v[64:67], v4 offset:256
    v_mfma_f32_16x16x32_bf16 v[44:47], v[92:95], v[88:91], v[44:47]
    ds_read_b64_tr_b16 v[72:73], v6 offset:0
    ds_read_b64_tr_b16 v[74:75], v6 offset:256
    s_add_u32 m0, s24, 32768
    v_mfma_f32_16x16x32_bf16 v[24:27], v[96:99], v[76:79], v[24:27]
    buffer_load_dwordx4 v1, s[4:7], s22 offen sc1 lds
    s_add_u32 s22, s22, 2048
    s_add_u32 m0, s24, 73728
    v_mfma_f32_16x16x32_bf16 v[32:35], v[96:99], v[80:83], v[32:35]
    buffer_load_dwordx4 v2, s[8:11], s23 offen lds
    s_add_u32 s23, s23, 65536
    v_mfma_f32_16x16x32_bf16 v[40:43], v[96:99], v[84:87], v[40:43]
    v_mfma_f32_16x16x32_bf16 v[48:51], v[96:99], v[88:91], v[48:51]
    s_waitcnt vmcnt(6) lgkmcnt(0)
    s_barrier
    v_mfma_f32_16x16x32_bf16 v[20:23], v[68:71], v[52:55], v[20:23]
    ds_read_b64_tr_b16 v[92:93], v5 offset:8192
    ds_read_b64_tr_b16 v[94:95], v5 offset:8448
    v_mfma_f32_16x16x32_bf16 v[28:31], v[68:71], v[56:59], v[28:31]
    ds_read_b128 v[76:79], v3 offset:8192
    ds_read_b128 v[80:83], v3 offset:8448
    v_mfma_f32_16x16x32_bf16 v[36:39], v[68:71], v[60:63], v[36:39]
    ds_read_b128 v[84:87], v4 offset:8192
    ds_read_b128 v[88:91], v4 offset:8448
    v_mfma_f32_16x16x32_bf16 v[44:47], v[68:71], v[64:67], v[44:47]
    ds_read_b64_tr_b16 v[96:97], v6 offset:8192
    ds_read_b64_tr_b16 v[98:99], v6 offset:8448
    s_add_u32 m0, s24, 0
    v_mfma_f32_16x16x32_bf16 v[24:27], v[72:75], v[52:55], v[24:27]
    buffer_load_dwordx4 v1, s[4:7], s22 offen sc1 lds
    s_add_u32 s22, s22, 2048
    s_add_u32 m0, s24, 40960
    v_mfma_f32_16x16x32_bf16 v[32:35], v[72:75], v[56:59], v[32:35]
    buffer_load_dwordx4 v2, s[8:11], s23 offen lds
    s_add_u32 s23, s23, 65536
    v_mfma_f32_16x16x32_bf16 v[40:43], v[72:75], v[60:63], v[40:43]
    v_mfma_f32_16x16x32_bf16 v[48:51], v[72:75], v[64:67], v[48:51]
    s_cmp_eq_u32 s27, 3
    s_cbranch_scc1 k2_kernel_d_sw
k2_kernel_d_b1:
    s_waitcnt vmcnt(6) lgkmcnt(0)
    s_barrier
    v_mfma_f32_16x16x32_bf16 v[20:23], v[92:95], v[76:79], v[20:23]
    ds_read_b64_tr_b16 v[68:69], v5 offset:16384
    ds_read_b64_tr_b16 v[70:71], v5 offset:16640
    v_mfma_f32_16x16x32_bf16 v[28:31], v[92:95], v[80:83], v[28:31]
    ds_read_b128 v[52:55], v3 offset:16384
    ds_read_b128 v[56:59], v3 offset:16640
    v_mfma_f32_16x16x32_bf16 v[36:39], v[92:95], v[84:87], v[36:39]
    ds_read_b128 v[60:63], v4 offset:16384
    ds_read_b128 v[64:67], v4 offset:16640
    v_mfma_f32_16x16x32_bf16 v[44:47], v[92:95], v[88:91], v[44:47]
    ds_read_b64_tr_b16 v[72:73], v6 offset:16384
    ds_read_b64_tr_b16 v[74:75], v6 offset:16640
    s_add_u32 m0, s24, 8192
    v_mfma_f32_16x16x32_bf16 v[24:27], v[96:99], v[76:79], v[24:27]
    buffer_load_dwordx4 v1, s[4:7], s22 offen sc1 lds
    s_add_u32 s22, s22, 2048
    s_add_u32 m0, s24, 49152
    v_mfma_f32_16x16x32_bf16 v[32:35], v[96:99], v[80:83], v[32:35]
    buffer_load_dwordx4 v2, s[8:11], s23 offen lds
    s_add_u32 s23, s23, 65536
    v_mfma_f32_16x16x32_bf16 v[40:43], v[96:99], v[84:87], v[40:43]
    v_mfma_f32_16x16x32_bf16 v[48:51], v[96:99], v[88:91], v[48:51]
    s_sub_u32 s27, s27, 1
    s_cmp_lg_u32 s27, 0
    s_cbranch_scc1 k2_kernel_d_loop
    s_sub_u32 s52, s2, 256
    s_lshl_b32 s52, s52, 3
    s_add_u32 s52, s52, s16
    s_lshl_b32 s52, s52, 11
    s_add_u32 s52, s52, 0x2400000
    s_xor_b32 s53, s52, 16384
    v_cvt_pk_bf16_f32 v100, v36, v37
    v_cvt_pk_bf16_f32 v101, v38, v39
    v_cvt_pk_bf16_f32 v102, v40, v41
    v_cvt_pk_bf16_f32 v103, v42, v43
    v_cvt_pk_bf16_f32 v104, v44, v45
    v_cvt_pk_bf16_f32 v105, v46, v47
    v_cvt_pk_bf16_f32 v106, v48, v49
    v_cvt_pk_bf16_f32 v107, v50, v51
    v_max_u32 v100, 1, v100
    v_max_u32 v101, 1, v101
    v_max_u32 v102, 1, v102
    v_max_u32 v103, 1, v103
    v_max_u32 v104, 1, v104
    v_max_u32 v105, 1, v105
    v_max_u32 v106, 1, v106
    v_max_u32 v107, 1, v107
    buffer_store_dwordx4 v[100:103], v1, s[12:15], s52 offen offset:0 sc1
    buffer_store_dwordx4 v[104:107], v1, s[12:15], s52 offen offset:1024 sc1
    v_and_b32 v18, 15, v0
    v_lshrrev_b32 v19, 4, v0
    v_lshlrev_b32 v18, 11, v18
    v_and_b32 v7, 1, v19
    v_lshl_add_u32 v18, v7, 5, v18
    v_lshrrev_b32 v19, 1, v19
    v_lshl_add_u32 v18, v19, 4, v18
    s_lshl_b32 s55, s36, 16
    s_lshl_b32 s30, s20, 8
    s_add_u32 s55, s55, s30
    s_lshl_b32 s30, s18, 6
    s_add_u32 s55, s55, s30
    s_add_u32 s56, s55, 32768
    s_mov_b32 s57, 0xffff0000
    s_waitcnt lgkmcnt(0)
k2_kernel_d_poll:
    buffer_load_dwordx4 v[108:111], v1, s[12:15], s53 offen sc1
    buffer_load_dwordx4 v[112:115], v1, s[12:15], s53 offen offset:1024 sc1
    s_waitcnt vmcnt(0)
    v_min3_u32 v17, v108, v109, v110
    v_min3_u32 v19, v111, v112, v113
    v_min3_u32 v17, v17, v114, v115
    v_min_u32 v17, v17, v19
    v_cmp_eq_u32 vcc, 0, v17
    s_nop 0
    s_cmp_lg_u64 vcc, 0
    s_cbranch_scc1 k2_kernel_d_poll
    v_lshlrev_b32 v52, 16, v108
    v_and_b32 v53, s57, v108
    v_lshlrev_b32 v54, 16, v109
    v_and_b32 v55, s57, v109
    v_lshlrev_b32 v56, 16, v110
    v_and_b32 v57, s57, v110
    v_lshlrev_b32 v58, 16, v111
    v_and_b32 v59, s57, v111
    v_add_f32 v20, v20, v52
    v_add_f32 v21, v21, v53
    v_add_f32 v22, v22, v54
    v_add_f32 v23, v23, v55
    v_add_f32 v24, v24, v56
    v_add_f32 v25, v25, v57
    v_add_f32 v26, v26, v58
    v_add_f32 v27, v27, v59
    v_cvt_pk_bf16_f32 v76, v20, v21
    v_cvt_pk_bf16_f32 v77, v22, v23
    v_cvt_pk_bf16_f32 v78, v24, v25
    v_cvt_pk_bf16_f32 v79, v26, v27
    s_nop 0
    v_permlane16_swap_b32 v76, v78
    v_permlane16_swap_b32 v77, v79
    buffer_store_dwordx4 v[76:79], v18, s[48:51], s55 offen
    v_lshlrev_b32 v52, 16, v112
    v_and_b32 v53, s57, v112
    v_lshlrev_b32 v54, 16, v113
    v_and_b32 v55, s57, v113
    v_lshlrev_b32 v56, 16, v114
    v_and_b32 v57, s57, v114
    v_lshlrev_b32 v58, 16, v115
    v_and_b32 v59, s57, v115
    v_add_f32 v28, v28, v52
    v_add_f32 v29, v29, v53
    v_add_f32 v30, v30, v54
    v_add_f32 v31, v31, v55
    v_add_f32 v32, v32, v56
    v_add_f32 v33, v33, v57
    v_add_f32 v34, v34, v58
    v_add_f32 v35, v35, v59
    v_cvt_pk_bf16_f32 v80, v28, v29
    v_cvt_pk_bf16_f32 v81, v30, v31
    v_cvt_pk_bf16_f32 v82, v32, v33
    v_cvt_pk_bf16_f32 v83, v34, v35
    s_nop 0
    v_permlane16_swap_b32 v80, v82
    v_permlane16_swap_b32 v81, v83
    buffer_store_dwordx4 v[80:83], v18, s[48:51], s56 offen
    s_endpgm
k2_kernel_d_fl:
    buffer_load_dword v11, v12, s[12:15], s37 offen sc1
    s_branch k2_kernel_d_b2
k2_kernel_d_sw:
    s_lshl_b32 s30, s21, 15
    s_add_u32 s22, s39, s30
    s_and_b32 s30, s22, 0xfffff800
    s_add_u32 s6, s30, 32768
    s_mov_b32 s8, s40
    s_mov_b32 s9, s41
    s_lshl_b32 s23, s21, 20
    s_add_u32 s10, s23, 1048576
    s_cmp_lg_u32 s16, 0
    s_cbranch_scc1 k2_kernel_d_b1
k2_kernel_d_sw2:
    v_cmp_eq_u32 vcc, 0, v11
    s_nop 0
    s_cmp_eq_u64 vcc, 0
    s_cbranch_scc1 k2_kernel_d_b1
    s_sleep 6
    buffer_load_dword v11, v12, s[12:15], s37 offen sc1
    s_waitcnt vmcnt(0)
    s_branch k2_kernel_d_sw2
k2_kernel_d_sc:
    s_nop 4
    v_sub_f32 v13, 1.0, v13
    v_sub_f32 v14, 1.0, v14
    v_sub_f32 v15, 1.0, v15
    v_sub_f32 v16, 1.0, v16
    v_mul_f32 v20, v20, v13
    v_mul_f32 v21, v21, v13
    v_mul_f32 v22, v22, v13
    v_mul_f32 v23, v23, v13
    v_mul_f32 v24, v24, v13
    v_mul_f32 v25, v25, v13
    v_mul_f32 v26, v26, v13
    v_mul_f32 v27, v27, v13
    v_mul_f32 v28, v28, v14
    v_mul_f32 v29, v29, v14
    v_mul_f32 v30, v30, v14
    v_mul_f32 v31, v31, v14
    v_mul_f32 v32, v32, v14
    v_mul_f32 v33, v33, v14
    v_mul_f32 v34, v34, v14
    v_mul_f32 v35, v35, v14
    v_mul_f32 v36, v36, v15
    v_mul_f32 v37, v37, v15
    v_mul_f32 v38, v38, v15
    v_mul_f32 v39, v39, v15
    v_mul_f32 v40, v40, v15
    v_mul_f32 v41, v41, v15
    v_mul_f32 v42, v42, v15
    v_mul_f32 v43, v43, v15
    v_mul_f32 v44, v44, v16
    v_mul_f32 v45, v45, v16
    v_mul_f32 v46, v46, v16
    v_mul_f32 v47, v47, v16
    v_mul_f32 v48, v48, v16
    v_mul_f32 v49, v49, v16
    v_mul_f32 v50, v50, v16
    v_mul_f32 v51, v51, v16
    s_branch k2_kernel_d_b2
k2_kernel_end:
    s_endpgm
.section .rodata,"a"
.p2align 6
.amdhsa_kernel k2_kernel
  .amdhsa_next_free_vgpr 128
  .amdhsa_next_free_sgpr 102
  .amdhsa_accum_offset 128
  .amdhsa_group_segment_fixed_size 0
  .amdhsa_kernarg_size 88
  .amdhsa_user_sgpr_count 2
  .amdhsa_user_sgpr_kernarg_segment_ptr 1
  .amdhsa_system_sgpr_workgroup_id_x 1
.end_amdhsa_kernel
```
